```python
import torch

def _softmax(x, axis=-1):
    return torch.softmax(x, dim=axis)
def _gelu(x):
    return torch.nn.functional.gelu(x, approximate="tanh")
def _silu(x):
    return torch.nn.functional.silu(x)
def _sigmoid(x):
    return torch.sigmoid(x)
def _layernorm(x, axis=-1, eps=1e-5):
    m = x.mean(dim=axis, keepdim=True)
    v = x.var(dim=axis, keepdim=True, unbiased=False)
    return (x - m) / torch.sqrt(v + eps)
def _scatter_add(tgt, idx, src, axis=0):
    return tgt.clone().index_add_(axis, idx, src)
def _segment_sum(src, seg, n):
    out = torch.zeros((n,) + src.shape[1:], dtype=src.dtype)
    return out.index_add_(0, seg, src)
def _pad(x, pw):
    flat = tuple(v for pair in reversed(pw) for v in pair)
    return torch.nn.functional.pad(x, flat)

kernel_name = 'gated_mix__ssm_conv_h3__dense_activation_gelu__prompt'

def setup_inputs():

    _w = (lambda a: (lambda t: t.to(torch.bfloat16) if t.is_floating_point() else t)(torch.as_tensor(a)))
    def _A_setup():
        B, S, D = 1, 2048, 448
        ks = 4
        return {
            "q": _w((lambda *s: torch.randn(*s, dtype=torch.bfloat16) * 0.05)(B, S, D)),
            "k": _w((lambda *s: torch.randn(*s, dtype=torch.bfloat16) * 0.8)(B, S, D)),
            "v": _w((lambda *s: torch.randn(*s, dtype=torch.bfloat16) * 0.8)(B, S, D)),
            "shift_k": _w((lambda *s: torch.randn(*s, dtype=torch.bfloat16) * 0.8)(D, ks) * 0.5),
            "ssm_k": _w((lambda *s: torch.randn(*s, dtype=torch.bfloat16) * 0.8)(D, S) * (1.0 / S ** 0.5)),
            "ssm_D": _w((lambda *s: torch.randn(*s, dtype=torch.bfloat16) * 0.8)(D)),
        }
    _A_in = _A_setup()

    def _B_setup():
        B, S, D, F = 1, 2048, 448, 1792
        return {
            "x": _w((lambda *s: torch.randn(*s, dtype=torch.bfloat16) * 0.05)(B, S, D)),
            "w1": _w((lambda *s: torch.randn(*s, dtype=torch.bfloat16) * 3.2)(D, F) * (D ** -0.5)),
            "b1": _w((lambda *s: torch.randn(*s, dtype=torch.bfloat16) * 3.2)(F) * 0.01),
            "w2": _w((lambda *s: torch.randn(*s, dtype=torch.bfloat16) * 1.6)(F, D) * (F ** -0.5)),
            "b2": _w((lambda *s: torch.randn(*s, dtype=torch.bfloat16) * 3.2)(D) * 0.01),
        }
    _B_in = _B_setup()

    return {
        "A_q": _A_in["q"],
        "A_k": _A_in["k"],
        "A_v": _A_in["v"],
        "A_shift_k": _A_in["shift_k"],
        "A_ssm_k": _A_in["ssm_k"],
        "A_ssm_D": _A_in["ssm_D"],
        "B_x": _B_in["x"],
        "B_w1": _B_in["w1"],
        "B_b1": _B_in["b1"],
        "B_w2": _B_in["w2"],
        "B_b2": _B_in["b2"],
        "gate_w": _w((lambda *s: torch.randn(*s, dtype=torch.bfloat16) * 0.05)(448) * 16.0),
    }

def reference(A_q, A_k, A_v, A_shift_k, A_ssm_k, A_ssm_D, B_x, B_w1, B_b1, B_w2, B_b2, gate_w):
    def _A_ref(q, k, v, shift_k, ssm_k, ssm_D):
        B, S, D = q.shape
        ks = shift_k.shape[-1]
        k_pad = _pad(k, ((0, 0), (ks - 1, 0), (0, 0)))
        k_shift = torch.zeros_like(k)
        for t in range(ks):
            k_shift = k_shift + k_pad[:, t:t + S, :] * shift_k[:, ks - 1 - t][None, None, :]
        kv = k_shift * v
        L = 2 * S
        kv_pad = _pad(kv, ((0, 0), (0, S), (0, 0)))
        kf_pad = _pad(ssm_k, ((0, 0), (0, S)))
        kv_f = (lambda x, axes=(-2,-1): torch.fft.rfft2(x.float(), dim=axes))(kv_pad[:, None, :, :], axes=(1, 2))
        kf_f = (lambda x, axes=(-2,-1): torch.fft.rfft2(x.float(), dim=axes))(kf_pad[:, None, :], axes=(1, 2))
        kf_f = (lambda x, *d: x.permute(*d))(kf_f, 1, 2, 0)
        y_f = kv_f * kf_f[None, :, :, :]
        y = (lambda x, s, axes=(-2,-1): torch.fft.irfft2(x, s=s, dim=axes).to(torch.bfloat16))(y_f, (1, L), axes=(1, 2))[:, 0, :S, :]
        y = y + kv * ssm_D[None, None, :]
        return q * y

    def _B_ref(x, w1, b1, w2, b2):
        h = torch.einsum("bsd,df->bsf", x, w1) + b1
        h = _gelu(h)
        return torch.einsum("bsf,fd->bsd", h, w2) + b2

    x = A_q
    g = _sigmoid((x * gate_w).sum(-1, keepdims=True))
    a = _A_ref(x, A_k, A_v, A_shift_k, A_ssm_k, A_ssm_D)
    b = _B_ref(x, B_w1, B_b1, B_w2, B_b2)
    return g * a + (1 - g) * b
```

```asm
; @launch grid=(256,1,1) block=(512,1,1) lds=163840
.amdgcn_target "amdgcn-amd-amdhsa--gfx950"
.text
.globl gated_mix__ssm_conv_h3__dense_activation_gelu__prompt_kernel
.p2align 12
.type gated_mix__ssm_conv_h3__dense_activation_gelu__prompt_kernel,@function
gated_mix__ssm_conv_h3__dense_activation_gelu__prompt_kernel:
  s_load_dwordx16 s[40:55], s[0:1], 0
  s_load_dwordx8 s[56:63], s[0:1], 64
  s_load_dwordx4 s[64:67], s[0:1], 96
  s_load_dwordx2 s[68:69], s[0:1], 112
  v_lshrrev_b32 v6, 6, v0
  v_and_b32 v1, 63, v0
  s_and_b32 s71, s2, 7
  v_readfirstlane_b32 s6, v6
  s_lshr_b32 s72, s2, 3
  s_and_b32 s70, s6, 3
  s_cmp_lt_u32 s2, 224
  s_cbranch_scc1 L_main
  s_getpc_b64 s[4:5]
  v_lshlrev_b32 v4, 7, v0
  v_min_u32 v4, L_code_end-gated_mix__ssm_conv_h3__dense_activation_gelu__prompt_kernel-128, v4
  global_load_dword v255, v4, s[4:5]
  s_branch L_spare
L_main:
  s_mul_i32 s73, s72, 37
  s_lshr_b32 s73, s73, 8
  s_mul_i32 s74, s73, 7
  s_sub_u32 s74, s72, s74
  s_lshr_b32 s78, s71, 1
  s_lshl_b32 s75, s78, 2
  s_add_u32 s75, s75, s73
  s_and_b32 s87, s71, 1
  s_lshl_b32 s77, s75, 1
  s_add_u32 s77, s77, s87
  s_mul_i32 s76, s87, 7
  s_add_u32 s76, s76, s74
  s_cmp_ge_u32 s6, 4
  s_cbranch_scc1 L_A
  v_and_b32 v64, 7, v1
  v_lshrrev_b32 v65, 3, v1
  v_and_b32 v67, 15, v1
  v_mul_u32_u24 v9, 896, v65
  s_lshl_b32 s84, s73, 1
  s_add_u32 s84, s84, s74
  s_add_u32 s84, s84, 0x6
  s_cmp_ge_u32 s84, 7
  s_cselect_b32 s78, 7, 0
  s_sub_u32 s84, s84, s78
  s_cmp_ge_u32 s84, 7
  s_cselect_b32 s78, 7, 0
  s_sub_u32 s84, s84, s78
  v_lshrrev_b32 v66, 4, v1
  s_xor_b32 s78, s70, s87
  s_andn2_b32 s78, 1, s78
  s_lshr_b32 s79, s70, 1
  s_mul_i32 s79, s79, 28672
  s_mul_i32 s81, s78, 57344
  s_add_u32 s79, s79, s81
  s_mul_i32 s81, s75, 114688
  s_add_u32 s79, s79, s81
  v_add_u32 v4, s79, v9
  v_xor_b32 v7, v64, v66
  v_lshl_add_u32 v68, v7, 4, v4
  v_xor_b32 v7, 4, v7
  v_lshl_add_u32 v69, v7, 4, v4
  v_add_u32 v70, 12288, v68
  v_add_u32 v71, 18432, v69
  v_add_u32 v69, 6144, v69
  s_lshl_b32 s88, s70, 12
  s_lshl_b32 s100, s84, 7
  s_mov_b32 s10, 0x1c0000
  s_mov_b32 s11, 0x20000
  v_and_b32 v7, 1, v66
  v_lshlrev_b32 v7, 2, v7
  v_xor_b32 v11, v64, v7
  s_mul_i32 s78, s70, 57344
  s_lshl_b32 s81, s76, 8
  s_add_u32 s78, s78, s81
  v_mul_u32_u24 v72, 3584, v65
  v_lshl_add_u32 v72, v11, 4, v72
  v_add_u32 v72, s78, v72
  v_xor_b32 v73, 32, v72
  v_add_u32 v73, 27648, v73
  v_add_u32 v74, 128, v72
  v_add_u32 v75, 128, v73
  s_add_u32 s89, s88, 16384
  s_mul_i32 s98, s84, 229376
  s_mov_b32 s26, 0x188000
  s_mov_b32 s27, 0x20000
  s_mov_b32 s14, 0x1c0000
  s_mov_b32 s15, 0x20000
  s_mov_b32 s18, 0x1c0000
  s_mov_b32 s19, 0x20000
  s_lshl_b32 s78, s74, 7
  v_lshl_add_u32 v10, v64, 4, s78
  s_mul_i32 s78, s77, 57344
  s_mul_i32 s81, s70, 14336
  s_add_u32 s78, s78, s81
  v_add3_u32 v78, v9, v10, s78
  s_add_u32 s78, s81, 7168
  v_subrev_u32 v79, s78, v78
  s_mov_b32 s5, 6144
  s_lshl_b32 s3, s70, 11
  s_lshl_b32 s78, s74, 9
  s_lshl_b32 s81, s70, 7
  s_add_u32 s78, s78, s81
  v_lshl_add_u32 v6, v64, 4, s78
  s_add_u32 s79, s81, 157696
  s_lshl_b32 s80, s74, 7
  s_lshl_b32 s81, s77, 2
  s_add_u32 s80, s80, s81
  s_add_u32 s86, s80, s70
  s_lshr_b32 s86, s86, 1
  s_lshl_b32 s7, s86, 12
  s_waitcnt lgkmcnt(0)
  s_mov_b64 s[8:9], s[40:41]
  s_mov_b64 s[24:25], s[54:55]
  s_mov_b64 s[12:13], s[42:43]
  s_mov_b64 s[16:17], s[44:45]
  s_add_u32 m0, s3, 132096
  s_nop 0
  buffer_load_dwordx4 v78, s[12:15], 0 offen lds
  buffer_load_dwordx4 v78, s[12:15], s5 offen offset:1024 lds
  s_add_u32 m0, s3, 140288
  s_nop 0
  buffer_load_dwordx4 v78, s[16:19], 0 offen lds
  buffer_load_dwordx4 v78, s[16:19], s5 offen offset:1024 lds
  s_mov_b32 m0, 131072
  s_mov_b32 exec_lo, 0
  buffer_load_dwordx4 v79, s[12:15], 0 offen lds
  s_mov_b32 exec_lo, -1
  s_mov_b32 m0, s79
  s_mov_b64 exec, 0xff
  global_load_lds_dwordx4 v6, s[46:47]
  s_mov_b64 exec, -1
  s_load_dword s82, s[68:69], 0
  s_load_dword s0, s[48:49], s7 offset:2044
  s_load_dword s83, s[50:51], s80
  s_and_b32 s6, s70, 1
  s_mov_b64 s[36:37], s[68:69]
  s_mov_b32 s38, 0x1200000
  s_mov_b32 s39, 0x20000
  s_mov_b64 s[28:29], s[58:59]
  s_mov_b32 s30, 0x188000
  s_mov_b32 s31, 0x20000
  s_mov_b64 s[20:21], s[48:49]
  s_mov_b32 s22, 0x1c0000
  s_mov_b32 s23, 0x20000
  s_mov_b64 s[32:33], s[64:65]
  s_mov_b32 s34, 0x1c0000
  s_mov_b32 s35, 0x20000
  v_and_b32 v28, 31, v1
  v_lshrrev_b32 v29, 5, v1
  v_and_b32 v8, 3, v1
  v_bfe_u32 v9, v1, 2, 2
  v_bfe_u32 v7, v1, 4, 1
  s_add_u32 s78, s73, 1
  s_and_b32 s78, s78, 3
  s_lshl_b32 s78, s78, 1
  s_add_u32 s78, s78, s74
  s_cmp_eq_u32 s78, 0
  s_cselect_b32 s78, 7, s78
  s_sub_u32 s78, s78, 1
  s_cmp_ge_u32 s78, 7
  s_cselect_b32 s79, 7, 0
  s_sub_u32 s78, s78, s79
  s_lshl_b32 s41, s78, 7
  s_mul_i32 s52, s78, 229376
  s_add_u32 s78, s73, 2
  s_and_b32 s78, s78, 3
  s_lshl_b32 s78, s78, 1
  s_add_u32 s78, s78, s74
  s_cmp_eq_u32 s78, 0
  s_cselect_b32 s78, 7, s78
  s_sub_u32 s78, s78, 1
  s_cmp_ge_u32 s78, 7
  s_cselect_b32 s79, 7, 0
  s_sub_u32 s78, s78, s79
  s_lshl_b32 s42, s78, 7
  s_mul_i32 s53, s78, 229376
  s_add_u32 s78, s73, 3
  s_and_b32 s78, s78, 3
  s_lshl_b32 s78, s78, 1
  s_add_u32 s78, s78, s74
  s_cmp_eq_u32 s78, 0
  s_cselect_b32 s78, 7, s78
  s_sub_u32 s78, s78, 1
  s_cmp_ge_u32 s78, 7
  s_cselect_b32 s79, 7, 0
  s_sub_u32 s78, s78, s79
  s_lshl_b32 s43, s78, 7
  s_mul_i32 s54, s78, 229376
  s_add_u32 s78, s74, 0
  s_cmp_ge_u32 s78, 7
  s_cselect_b32 s79, 7, 0
  s_sub_u32 s78, s78, s79
  s_lshl_b32 s44, s78, 7
  s_mul_i32 s55, s78, 229376
  s_add_u32 s78, s74, 2
  s_cmp_ge_u32 s78, 7
  s_cselect_b32 s79, 7, 0
  s_sub_u32 s78, s78, s79
  s_lshl_b32 s45, s78, 7
  s_mul_i32 s58, s78, 229376
  s_add_u32 s78, s74, 4
  s_cmp_ge_u32 s78, 7
  s_cselect_b32 s79, 7, 0
  s_sub_u32 s78, s78, s79
  s_lshl_b32 s48, s78, 7
  s_mul_i32 s59, s78, 229376
  v_lshlrev_b32 v18, 4, v1
  v_mov_b32 v19, 1
  s_lshl_b32 s78, s70, 2
  s_add_u32 s78, s78, 0x27f00
  v_mov_b32 v15, s78
  v_lshlrev_b32 v16, 2, v8
  v_add_u32 v16, 0x27f00, v16
  v_and_b32 v4, 1, v1
  v_bfe_u32 v5, v1, 1, 1
  v_bfe_u32 v6, v1, 3, 1
  s_lshl_b32 s79, s6, 13
  v_lshl_add_u32 v25, v29, 9, s79
  v_lshl_add_u32 v25, v9, 7, v25
  v_lshl_add_u32 v25, v6, 6, v25
  v_lshl_add_u32 v25, v7, 5, v25
  v_lshl_add_u32 v25, v4, 4, v25
  v_lshl_add_u32 v25, v5, 3, v25
  s_lshl_b32 s79, s6, 6
  v_xor_b32 v25, s79, v25
  v_xor_b32 v24, 64, v25
  v_add_u32 v26, 0x10000, v24
  v_add_u32 v27, 0x10000, v25
  s_mul_i32 s90, s74, 114688
  s_lshr_b32 s78, s71, 1
  s_mul_i32 s78, s78, 3
  s_add_u32 s78, s78, 1
  s_lshr_b32 s78, s78, 1
  s_add_u32 s78, s78, s74
  s_mul_i32 s78, s78, 114688
  s_cmp_ge_u32 s78, 802816
  s_cselect_b32 s79, 802816, 0
  s_sub_u32 s78, s78, s79
  s_add_u32 s80, s90, 114688
  s_cmp_ge_u32 s80, 802816
  s_cselect_b32 s80, 0, s80
  s_add_u32 s91, s78, 114688
  s_cmp_ge_u32 s91, 802816
  s_cselect_b32 s91, 0, s91
  s_add_u32 s92, s91, 114688
  s_cmp_ge_u32 s92, 802816
  s_cselect_b32 s92, 0, s92
  s_add_u32 m0, s88, 0
  s_nop 0
  buffer_load_dwordx4 v68, s[8:11], s100 offen offset:0 lds
  buffer_load_dwordx4 v69, s[8:11], s100 offen offset:1024 lds
  buffer_load_dwordx4 v70, s[8:11], s100 offen offset:2048 lds
  buffer_load_dwordx4 v71, s[8:11], s100 offen offset:3072 lds
  s_cmp_eq_u32 s92, s90
  s_cselect_b32 s92, s80, s92
  s_add_u32 s93, s92, 114688
  s_cmp_ge_u32 s93, 802816
  s_cselect_b32 s93, 0, s93
  s_cmp_eq_u32 s93, s90
  s_cselect_b32 s93, s80, s93
  s_add_u32 s94, s93, 114688
  s_cmp_ge_u32 s94, 802816
  s_cselect_b32 s94, 0, s94
  s_cmp_eq_u32 s94, s90
  s_cselect_b32 s94, s80, s94
  s_add_u32 s95, s94, 114688
  s_cmp_ge_u32 s95, 802816
  s_cselect_b32 s95, 0, s95
  s_cmp_eq_u32 s95, s90
  s_cselect_b32 s95, s80, s95
  s_add_u32 s96, s95, 114688
  s_cmp_ge_u32 s96, 802816
  s_cselect_b32 s96, 0, s96
  s_cmp_eq_u32 s96, s90
  s_cselect_b32 s96, s80, s96
  s_mov_b32 s61, 0x10001
  v_xor_b32 v48, 4, v15
  v_mov_b32 v52, 0
  v_mov_b32 v53, 0
  v_mov_b32 v54, 0
  v_mov_b32 v55, 0
  s_mul_i32 s4, s70, 11920
  s_add_u32 s4, s4, 0x1c000
  s_lshl_b32 s79, s6, 11
  s_add_u32 s7, s7, s79
  s_lshl_b32 s79, s74, 7
  s_mul_i32 s81, s70, 14336
  s_add_u32 s79, s79, s81
  s_mul_i32 s81, s87, 802816
  s_add_u32 s79, s79, s81
  v_mul_u32_u24 v30, 896, v65
  v_lshl_add_u32 v30, v11, 4, v30
  v_add_u32 v30, s79, v30
  v_add_u32 v31, 6144, v30
  v_add_u32 v32, 57344, v30
  v_add_u32 v33, 57344, v31
  v_and_b32 v4, 1, v1
  v_bfe_u32 v5, v1, 1, 1
  s_add_u32 s78, s4, 96
  v_lshl_add_u32 v34, v4, 5, s78
  v_lshl_add_u32 v34, v7, 4, v34
  v_lshl_add_u32 v34, v5, 3, v34
  v_lshlrev_b32 v4, 6, v29
  v_lshl_add_u32 v4, v9, 3, v4
  v_sub_u32 v34, v34, v4
  s_add_u32 s78, s4, 4176
  v_mul_u32_u24 v35, 1280, v7
  v_lshl_add_u32 v35, v67, 4, v35
  v_lshl_add_u32 v35, v29, 4, v35
  v_add_u32 v35, s78, v35
  s_mul_i32 s78, s86, 4224
  s_lshl_b32 s81, s6, 4
  s_add_u32 s78, s78, s81
  s_add_u32 s78, s78, 0x100000
  v_lshl_add_u32 v36, v1, 5, s78
  s_add_u32 s78, s4, 4416
  v_lshl_add_u32 v37, v1, 3, s78
  s_add_u32 s78, s4, 4160
  v_mul_u32_u24 v38, 1280, v7
  v_lshl_add_u32 v38, v67, 4, v38
  v_add_u32 v38, s78, v38
  v_lshl_add_u32 v4, v28, 4, s4
  v_cmp_gt_u32 vcc, 32, v1
  s_nop 1
  v_cndmask_b32 v38, v4, v38, vcc
  s_add_u32 s78, s4, 6784
  v_writelane_b32 v38, s78, 36
  v_lshlrev_b32 v4, 2, v67
  v_lshl_add_u32 v4, v66, 0, v4
  v_add_u32 v4, 0x1, v4
  v_lshrrev_b32 v5, 2, v4
  v_lshl_add_u32 v40, v5, 6, s78
  v_lshl_add_u32 v40, v4, 2, v40
  s_add_u32 s78, s4, 6720
  v_mul_u32_u24 v39, 80, v67
  v_lshl_add_u32 v39, v66, 4, v39
  v_add_u32 v39, s78, v39
  s_lshr_b32 s79, s70, 1
  s_mul_i32 s80, s79, 23840
  s_add_u32 s80, s80, 0x1c000
  s_mul_i32 s78, s6, 2560
  s_add_u32 s78, s78, s80
  s_add_u32 s78, s78, 0x1a40
  v_lshrrev_b32 v4, 2, v1
  v_lshl_add_u32 v41, v1, 4, s78
  v_lshl_add_u32 v41, v4, 4, v41
  v_lshl_add_u32 v42, v1, 2, s78
  v_lshl_add_u32 v42, v4, 6, v42
  s_lshl_b32 s78, s6, 11
  s_add_u32 s78, s78, s80
  s_add_u32 s78, s78, 0x40
  v_add_u32 v43, s78, v18
  s_lshr_b32 s78, s77, 3
  s_lshl_b32 s64, s74, 11
  s_lshl_b32 s81, s78, 9
  s_add_u32 s64, s64, s81
  s_lshl_b32 s81, s70, 7
  s_add_u32 s64, s64, s81
  s_add_u32 s64, s64, 0x60000
  s_mul_i32 s79, s75, 43
  s_lshr_b32 s79, s79, 7
  s_mul_i32 s80, s79, 1507328
  s_lshl_b32 s81, s75, 15
  s_add_u32 s80, s80, s81
  s_mul_i32 s81, s87, 802816
  s_add_u32 s80, s80, s81
  s_lshl_b32 s81, s70, 13
  s_add_u32 s80, s80, s81
  s_add_u32 s80, s80, 0x501000
  v_add_u32 v44, s80, v18
  s_lshr_b32 s79, s70, 1
  s_mul_i32 s78, s77, 57344
  s_mul_i32 s81, s79, 28672
  s_add_u32 s78, s78, s81
  s_lshl_b32 s81, s74, 7
  s_add_u32 s78, s78, s81
  s_lshl_b32 s81, s6, 6
  s_add_u32 s78, s78, s81
  v_mul_u32_u24 v45, 896, v4
  v_lshl_add_u32 v45, v8, 4, v45
  v_add_u32 v45, s78, v45
  s_mov_b32 s56, 14336
  v_add_u32 v46, s4, v18
  s_xor_b32 s79, s70, 1
  s_mul_i32 s78, s79, 11920
  s_add_u32 s78, s78, 0x1c000
  v_add_u32 v47, s78, v18
  v_mul_u32_u24 v49, 80, v28
  v_lshl_add_u32 v49, v29, 4, v49
  v_add_u32 v49, s4, v49
  v_mul_u32_u24 v50, 80, v4
  v_lshl_add_u32 v50, v8, 4, v50
  v_add_u32 v50, s4, v50
  v_lshl_add_u32 v51, v1, 2, s4
  s_lshl_b32 s62, s77, 10
  s_lshl_b32 s81, s70, 8
  s_add_u32 s62, s62, s81
  s_add_u32 s62, s62, 0x80080
  s_mul_i32 s63, s86, 4224
  s_lshl_b32 s81, s6, 11
  s_add_u32 s63, s63, s81
  s_add_u32 s63, s63, 0x300000
  s_mul_i32 s60, s77, 114688
  s_lshl_b32 s81, s74, 14
  s_add_u32 s60, s60, s81
  s_lshl_b32 s81, s70, 12
  s_add_u32 s60, s60, s81
  s_add_u32 s60, s60, 0xe40000
  s_waitcnt lgkmcnt(0)
  s_add_u32 s82, s82, 0x9e3779b9
  s_mov_b32 s101, s83
  s_mov_b32 s83, s82
  v_mov_b32 v2, s82
  v_lshlrev_b32 v23, 3, v1
  v_bfe_u32 v23, v2, v23, 8
  v_lshl_or_b32 v23, v23, 15, v23
  v_and_b32 v20, s61, v23
  v_lshrrev_b32 v21, 2, v23
  v_and_b32 v21, s61, v21
  v_lshrrev_b32 v22, 4, v23
  v_and_b32 v22, s61, v22
  v_lshrrev_b32 v23, 6, v23
  v_and_b32 v23, s61, v23
  s_lshl_b32 s78, s70, 3
  s_and_b32 s78, s78, 16
  s_lshr_b32 s101, s101, s78
  s_lshl_b32 s101, s101, 16
  s_cmp_eq_u32 s6, 0
  s_cselect_b32 s101, s101, 0
  s_cselect_b32 s0, 0, s0
  s_waitcnt vmcnt(4)
  s_barrier
  s_waitcnt vmcnt(7)
  s_add_u32 m0, s89, 0
  s_nop 0
  buffer_load_dwordx4 v72, s[24:27], s98 offen offset:0 lds
  s_waitcnt vmcnt(7)
  buffer_load_dwordx4 v73, s[24:27], s98 offen offset:1024 lds
  s_waitcnt vmcnt(7)
  s_add_u32 m0, s89, 2048
  s_nop 0
  buffer_load_dwordx4 v74, s[24:27], s98 offen offset:0 lds
  s_waitcnt vmcnt(7)
  buffer_load_dwordx4 v75, s[24:27], s98 offen offset:1024 lds
  s_waitcnt vmcnt(7)
  s_add_u32 m0, s88, 32768
  s_nop 0
  buffer_load_dwordx4 v68, s[8:11], s41 offen offset:0 lds
  s_waitcnt vmcnt(7)
  buffer_load_dwordx4 v69, s[8:11], s41 offen offset:1024 lds
  s_waitcnt vmcnt(7)
  buffer_load_dwordx4 v70, s[8:11], s41 offen offset:2048 lds
  s_waitcnt vmcnt(7)
  buffer_load_dwordx4 v71, s[8:11], s41 offen offset:3072 lds
  s_mov_b64 exec, 0
  s_branch L_stub0
L_back:
  s_mov_b64 exec, -1
  s_waitcnt vmcnt(7)
  s_add_u32 m0, s89, 32768
  s_nop 0
  buffer_load_dwordx4 v72, s[24:27], s52 offen offset:0 lds
  s_waitcnt vmcnt(7)
  buffer_load_dwordx4 v73, s[24:27], s52 offen offset:1024 lds
  s_waitcnt vmcnt(7)
  s_add_u32 m0, s89, 34816
  s_nop 0
  buffer_load_dwordx4 v74, s[24:27], s52 offen offset:0 lds
  s_waitcnt vmcnt(7)
  buffer_load_dwordx4 v75, s[24:27], s52 offen offset:1024 lds
  s_barrier
  s_add_u32 m0, s88, 65536
  s_nop 0
  buffer_load_dwordx4 v68, s[8:11], s42 offen offset:0 lds
  buffer_load_dwordx4 v69, s[8:11], s42 offen offset:1024 lds
  buffer_load_dwordx4 v70, s[8:11], s42 offen offset:2048 lds
  buffer_load_dwordx4 v71, s[8:11], s42 offen offset:3072 lds
  s_add_u32 m0, s89, 65536
  s_nop 0
  buffer_load_dwordx4 v72, s[24:27], s53 offen offset:0 lds
  buffer_load_dwordx4 v73, s[24:27], s53 offen offset:1024 lds
  s_waitcnt vmcnt(6)
  s_barrier
  s_add_u32 m0, s89, 67584
  s_nop 0
  buffer_load_dwordx4 v74, s[24:27], s53 offen offset:0 lds
  buffer_load_dwordx4 v75, s[24:27], s53 offen offset:1024 lds
  s_add_u32 m0, s88, 98304
  s_nop 0
  buffer_load_dwordx4 v68, s[8:11], s43 offen offset:0 lds
  buffer_load_dwordx4 v69, s[8:11], s43 offen offset:1024 lds
  buffer_load_dwordx4 v70, s[8:11], s43 offen offset:2048 lds
  buffer_load_dwordx4 v71, s[8:11], s43 offen offset:3072 lds
  s_add_u32 m0, s89, 98304
  s_nop 0
  buffer_load_dwordx4 v72, s[24:27], s54 offen offset:0 lds
  buffer_load_dwordx4 v73, s[24:27], s54 offen offset:1024 lds
  s_add_u32 m0, s89, 100352
  s_nop 0
  buffer_load_dwordx4 v74, s[24:27], s54 offen offset:0 lds
  buffer_load_dwordx4 v75, s[24:27], s54 offen offset:1024 lds
  s_add_u32 m0, s88, 0
  s_nop 0
  buffer_load_dwordx4 v68, s[8:11], s44 offen offset:0 lds
  buffer_load_dwordx4 v69, s[8:11], s44 offen offset:1024 lds
  buffer_load_dwordx4 v70, s[8:11], s44 offen offset:2048 lds
  buffer_load_dwordx4 v71, s[8:11], s44 offen offset:3072 lds
  s_waitcnt vmcnt(12)
  s_barrier
  s_add_u32 m0, s89, 0
  s_nop 0
  buffer_load_dwordx4 v72, s[24:27], s55 offen offset:0 lds
  buffer_load_dwordx4 v73, s[24:27], s55 offen offset:1024 lds
  s_add_u32 m0, s89, 2048
  s_nop 0
  buffer_load_dwordx4 v74, s[24:27], s55 offen offset:0 lds
  buffer_load_dwordx4 v75, s[24:27], s55 offen offset:1024 lds
  buffer_load_dwordx4 v[192:195], v18, s[20:23], s7 offen offset:0
  buffer_load_dwordx4 v[196:199], v18, s[20:23], s7 offen offset:1024
  s_add_u32 m0, s88, 32768
  s_nop 0
  buffer_load_dwordx4 v68, s[8:11], s45 offen offset:0 lds
  buffer_load_dwordx4 v69, s[8:11], s45 offen offset:1024 lds
  s_waitcnt vmcnt(12)
  s_barrier
  s_load_dwordx8 s[12:19], s[36:37], s64 glc
  buffer_load_dwordx4 v70, s[8:11], s45 offen offset:2048 lds
  buffer_load_dwordx4 v71, s[8:11], s45 offen offset:3072 lds
  s_add_u32 m0, s89, 32768
  s_nop 0
  buffer_load_dwordx4 v72, s[24:27], s58 offen offset:0 lds
  buffer_load_dwordx4 v73, s[24:27], s58 offen offset:1024 lds
  s_add_u32 m0, s89, 34816
  s_nop 0
  buffer_load_dwordx4 v74, s[24:27], s58 offen offset:0 lds
  buffer_load_dwordx4 v75, s[24:27], s58 offen offset:1024 lds
  s_add_u32 m0, s88, 65536
  s_nop 0
  buffer_load_dwordx4 v68, s[8:11], s48 offen offset:0 lds
  buffer_load_dwordx4 v69, s[8:11], s48 offen offset:1024 lds
  s_mov_b32 s85, 0
  s_branch L_c_pu
L_rt_pu:
  s_sleep 1
  s_add_u32 s85, s85, 1
  s_cmp_gt_u32 s85, 0x40000
  s_cbranch_scc1 L_ok_pu
  s_load_dwordx8 s[12:19], s[36:37], s64 glc
L_c_pu:
  s_waitcnt lgkmcnt(0)
  s_cmp_lg_u64 s[12:13], s[82:83]
  s_cbranch_scc1 L_rt_pu
  s_cmp_lg_u64 s[14:15], s[82:83]
  s_cbranch_scc1 L_rt_pu
  s_cmp_lg_u64 s[16:17], s[82:83]
  s_cbranch_scc1 L_rt_pu
  s_cmp_lg_u64 s[18:19], s[82:83]
  s_cbranch_scc1 L_rt_pu
L_ok_pu:
  s_waitcnt vmcnt(12)
  s_barrier
  buffer_load_dwordx4 v70, s[8:11], s48 offen offset:2048 lds
  buffer_load_dwordx4 v71, s[8:11], s48 offen offset:3072 lds
  s_add_u32 m0, s89, 65536
  s_nop 0
  buffer_load_dwordx4 v72, s[24:27], s59 offen offset:0 lds
  buffer_load_dwordx4 v73, s[24:27], s59 offen offset:1024 lds
  s_add_u32 m0, s89, 67584
  s_nop 0
  buffer_load_dwordx4 v74, s[24:27], s59 offen offset:0 lds
  buffer_load_dwordx4 v75, s[24:27], s59 offen offset:1024 lds
  s_add_u32 m0, s3, 98304
  s_nop 0
  buffer_load_dwordx4 v30, s[28:31], s90 offen offset:0 lds
  buffer_load_dwordx4 v31, s[28:31], s90 offen offset:1024 lds
  s_add_u32 m0, s3, 106496
  s_nop 0
  buffer_load_dwordx4 v32, s[28:31], s90 offen offset:0 lds
  buffer_load_dwordx4 v33, s[28:31], s90 offen offset:1024 lds
  s_waitcnt vmcnt(12)
  s_barrier
  s_add_u32 m0, s3, 0
  s_nop 0
  buffer_load_dwordx4 v30, s[28:31], s91 offen offset:0 lds
  buffer_load_dwordx4 v31, s[28:31], s91 offen offset:1024 lds
  buffer_load_dwordx4 v[212:215], v36, s[36:39], 0 offen offset:0 sc1
  buffer_load_dwordx4 v[216:219], v36, s[36:39], 0 offen offset:2048 sc1
  s_add_u32 m0, s3, 8192
  s_nop 0
  buffer_load_dwordx4 v32, s[28:31], s91 offen offset:0 lds
  buffer_load_dwordx4 v33, s[28:31], s91 offen offset:1024 lds
  s_add_u32 m0, s3, 16384
  s_nop 0
  buffer_load_dwordx4 v30, s[28:31], s92 offen offset:0 lds
  buffer_load_dwordx4 v31, s[28:31], s92 offen offset:1024 lds
  s_waitcnt vmcnt(12)
  s_barrier
  s_add_u32 m0, s3, 24576
  s_nop 0
  buffer_load_dwordx4 v32, s[28:31], s92 offen offset:0 lds
  buffer_load_dwordx4 v33, s[28:31], s92 offen offset:1024 lds
  s_add_u32 m0, s3, 32768
  s_nop 0
  buffer_load_dwordx4 v30, s[28:31], s93 offen offset:0 lds
  buffer_load_dwordx4 v31, s[28:31], s93 offen offset:1024 lds
  s_add_u32 m0, s3, 40960
  s_nop 0
  buffer_load_dwordx4 v32, s[28:31], s93 offen offset:0 lds
  buffer_load_dwordx4 v33, s[28:31], s93 offen offset:1024 lds
  s_add_u32 m0, s3, 49152
  s_nop 0
  buffer_load_dwordx4 v30, s[28:31], s94 offen offset:0 lds
  buffer_load_dwordx4 v31, s[28:31], s94 offen offset:1024 lds
  s_add_u32 m0, s3, 57344
  s_nop 0
  buffer_load_dwordx4 v32, s[28:31], s94 offen offset:0 lds
  buffer_load_dwordx4 v33, s[28:31], s94 offen offset:1024 lds
  v_mov_b32 v208, s0
  s_mov_b32 exec_hi, 31
  ds_write_b128 v38, v[52:55]
  s_mov_b32 exec_hi, -1
  v_lshlrev_b32 v4, 16, v192
  v_and_b32 v5, 0xffff0000, v192
  v_add_f32 v4, s101, v4
  v_readlane_b32 s78, v195, 63
  s_mov_b64 exec, 1
  v_cvt_pk_bf16_f32 v192, v4, v5
  s_mov_b64 exec, -1
  v_mov_b32 v209, s78
  v_mov_b32_dpp v208, v195 wave_shr:1 row_mask:0xf bank_mask:0xf
  s_nop 0
  v_mov_b32_dpp v209, v199 wave_shr:1 row_mask:0xf bank_mask:0xf
  ds_write_b128 v43, v[192:195] offset:0
  v_alignbit_b32 v200, v192, v208, 16
  v_alignbit_b32 v201, v193, v192, 16
  v_alignbit_b32 v202, v194, v193, 16
  v_alignbit_b32 v203, v195, v194, 16
  ds_write_b128 v43, v[196:199] offset:1024
  v_alignbit_b32 v204, v196, v209, 16
  v_alignbit_b32 v205, v197, v196, 16
  v_alignbit_b32 v206, v198, v197, 16
  v_alignbit_b32 v207, v199, v198, 16
  ds_write_b128 v43, v[200:203] offset:11920
  ds_write_b128 v43, v[204:207] offset:12944
  ds_write_b32 v15, v19 offset:16
  s_waitcnt vmcnt(14)
  ds_write2_b64 v37, v[212:213], v[214:215] offset0:0 offset1:160
  ds_write2_b64 v37, v[216:217], v[218:219] offset0:64 offset1:224
  s_mov_b32 s85, 0
L_rt_lh:
  ds_read_b32 v17, v48 offset:16
  ds_read_b64_tr_b16 v[64:65], v34 offset:32
  ds_read_b64_tr_b16 v[66:67], v34 offset:0
  ds_read_b64_tr_b16 v[72:73], v34 offset:1056
  ds_read_b64_tr_b16 v[74:75], v34 offset:1024
  ds_read_b64_tr_b16 v[80:81], v34 offset:2080
  ds_read_b64_tr_b16 v[82:83], v34 offset:2048
  ds_read_b64_tr_b16 v[88:89], v34 offset:3104
  ds_read_b64_tr_b16 v[90:91], v34 offset:3072
  s_waitcnt lgkmcnt(8)
  v_cmp_eq_u32 vcc, 0, v17
  s_nop 0
  s_cbranch_vccz L_ok_lh
  s_sleep 1
  s_add_u32 s85, s85, 1
  s_cmp_lt_u32 s85, 0x400000
  s_cbranch_scc1 L_rt_lh
L_ok_lh:
  ds_read_b128 v[68:71], v35 offset:224
  ds_read_b128 v[76:79], v35 offset:480
  ds_read_b128 v[84:87], v35 offset:736
  ds_read_b128 v[92:95], v35 offset:992
  s_mov_b32 s85, 0
L_rt_lg:
  ds_read_b32 v17, v16 offset:48
  s_waitcnt lgkmcnt(0)
  v_cmp_eq_u32 vcc, 0, v17
  s_nop 0
  s_cbranch_vccz L_ok_lg
  s_sleep 1
  s_add_u32 s85, s85, 1
  s_cmp_lt_u32 s85, 0x400000
  s_cbranch_scc1 L_rt_lg
L_ok_lg:
  s_setprio 2
  v_mfma_f32_32x32x16_bf16 v[128:143], v[64:67], v[68:71], 0
  ds_read_b64_tr_b16 v[96:97], v34 offset:160
  ds_read_b64_tr_b16 v[98:99], v34 offset:128
  v_mfma_f32_32x32x16_bf16 v[144:159], v[64:67], v[76:79], 0
  s_add_u32 m0, s3, 65536
  s_nop 0
  buffer_load_dwordx4 v30, s[28:31], s95 offen offset:0 lds
  ds_read_b64_tr_b16 v[104:105], v34 offset:1184
  v_mfma_f32_32x32x16_bf16 v[160:175], v[64:67], v[84:87], 0
  ds_read_b64_tr_b16 v[106:107], v34 offset:1152
  ds_read_b64_tr_b16 v[112:113], v34 offset:2208
  v_mfma_f32_32x32x16_bf16 v[176:191], v[64:67], v[92:95], 0
  buffer_load_dwordx4 v31, s[28:31], s95 offen offset:1024 lds
  ds_read_b64_tr_b16 v[114:115], v34 offset:2176
  ds_read_b64_tr_b16 v[120:121], v34 offset:3232
  v_mfma_f32_32x32x16_bf16 v[144:159], v[72:75], v[68:71], v[144:159]
  ds_read_b64_tr_b16 v[122:123], v34 offset:3200
  ds_read_b128 v[100:103], v35 offset:192
  v_mfma_f32_32x32x16_bf16 v[160:175], v[72:75], v[76:79], v[160:175]
L_stub0:
  s_cbranch_execz L_stub1
  ds_read_b128 v[108:111], v35 offset:448
  v_mfma_f32_32x32x16_bf16 v[176:191], v[72:75], v[84:87], v[176:191]
  s_add_u32 m0, s3, 73728
  s_nop 0
  buffer_load_dwordx4 v32, s[28:31], s95 offen offset:0 lds
  ds_read_b128 v[116:119], v35 offset:704
  ds_read_b128 v[124:127], v35 offset:960
  v_mfma_f32_32x32x16_bf16 v[160:175], v[80:83], v[68:71], v[160:175]
  v_mfma_f32_32x32x16_bf16 v[176:191], v[80:83], v[76:79], v[176:191]
  buffer_load_dwordx4 v33, s[28:31], s95 offen offset:1024 lds
  v_mfma_f32_32x32x16_bf16 v[176:191], v[88:91], v[68:71], v[176:191]
  s_waitcnt lgkmcnt(0)
  v_mfma_f32_32x32x16_bf16 v[128:143], v[96:99], v[100:103], v[128:143]
  ds_read_b64_tr_b16 v[64:65], v34 offset:288
  ds_read_b64_tr_b16 v[66:67], v34 offset:256
  v_mfma_f32_32x32x16_bf16 v[144:159], v[96:99], v[108:111], v[144:159]
  s_add_u32 m0, s3, 81920
  s_nop 0
  buffer_load_dwordx4 v30, s[28:31], s96 offen offset:0 lds
  ds_read_b64_tr_b16 v[72:73], v34 offset:1312
  v_mfma_f32_32x32x16_bf16 v[160:175], v[96:99], v[116:119], v[160:175]
  ds_read_b64_tr_b16 v[74:75], v34 offset:1280
  ds_read_b64_tr_b16 v[80:81], v34 offset:2336
  v_mfma_f32_32x32x16_bf16 v[176:191], v[96:99], v[124:127], v[176:191]
  buffer_load_dwordx4 v31, s[28:31], s96 offen offset:1024 lds
  ds_read_b64_tr_b16 v[82:83], v34 offset:2304
  ds_read_b64_tr_b16 v[88:89], v34 offset:3360
  v_mfma_f32_32x32x16_bf16 v[144:159], v[104:107], v[100:103], v[144:159]
  ds_read_b64_tr_b16 v[90:91], v34 offset:3328
  ds_read_b128 v[68:71], v35 offset:160
  v_mfma_f32_32x32x16_bf16 v[160:175], v[104:107], v[108:111], v[160:175]
  ds_read_b128 v[76:79], v35 offset:416
  v_mfma_f32_32x32x16_bf16 v[176:191], v[104:107], v[116:119], v[176:191]
  s_add_u32 m0, s3, 90112
  s_nop 0
  buffer_load_dwordx4 v32, s[28:31], s96 offen offset:0 lds
  ds_read_b128 v[84:87], v35 offset:672
  ds_read_b128 v[92:95], v35 offset:928
  v_mfma_f32_32x32x16_bf16 v[160:175], v[112:115], v[100:103], v[160:175]
  v_mfma_f32_32x32x16_bf16 v[176:191], v[112:115], v[108:111], v[176:191]
  buffer_load_dwordx4 v33, s[28:31], s96 offen offset:1024 lds
  v_mfma_f32_32x32x16_bf16 v[176:191], v[120:123], v[100:103], v[176:191]
  s_waitcnt lgkmcnt(0)
  v_mfma_f32_32x32x16_bf16 v[128:143], v[64:67], v[68:71], v[128:143]
  ds_read_b64_tr_b16 v[96:97], v34 offset:416
  ds_read_b64_tr_b16 v[98:99], v34 offset:384
  v_mfma_f32_32x32x16_bf16 v[144:159], v[64:67], v[76:79], v[144:159]
  ds_read_b64_tr_b16 v[104:105], v34 offset:1440
  v_mfma_f32_32x32x16_bf16 v[160:175], v[64:67], v[84:87], v[160:175]
  ds_read_b64_tr_b16 v[106:107], v34 offset:1408
  ds_read_b64_tr_b16 v[112:113], v34 offset:2464
  v_mfma_f32_32x32x16_bf16 v[176:191], v[64:67], v[92:95], v[176:191]
  ds_read_b64_tr_b16 v[114:115], v34 offset:2432
  ds_read_b64_tr_b16 v[120:121], v34 offset:3488
  v_mfma_f32_32x32x16_bf16 v[144:159], v[72:75], v[68:71], v[144:159]
  ds_read_b64_tr_b16 v[122:123], v34 offset:3456
  ds_read_b128 v[100:103], v35 offset:128
  v_mfma_f32_32x32x16_bf16 v[160:175], v[72:75], v[76:79], v[160:175]
  ds_read_b128 v[108:111], v35 offset:384
  v_mfma_f32_32x32x16_bf16 v[176:191], v[72:75], v[84:87], v[176:191]
  ds_read_b128 v[116:119], v35 offset:640
  ds_read_b128 v[124:127], v35 offset:896
  v_mfma_f32_32x32x16_bf16 v[160:175], v[80:83], v[68:71], v[160:175]
  v_mfma_f32_32x32x16_bf16 v[176:191], v[80:83], v[76:79], v[176:191]
  v_mfma_f32_32x32x16_bf16 v[176:191], v[88:91], v[68:71], v[176:191]
  s_waitcnt lgkmcnt(0)
  v_mfma_f32_32x32x16_bf16 v[128:143], v[96:99], v[100:103], v[128:143]
  ds_read_b64_tr_b16 v[64:65], v34 offset:544
  ds_read_b64_tr_b16 v[66:67], v34 offset:512
  v_mfma_f32_32x32x16_bf16 v[144:159], v[96:99], v[108:111], v[144:159]
  ds_read_b64_tr_b16 v[72:73], v34 offset:1568
  v_mfma_f32_32x32x16_bf16 v[160:175], v[96:99], v[116:119], v[160:175]
  s_waitcnt vmcnt(12)
  ds_read_b64_tr_b16 v[74:75], v34 offset:1536
  ds_read_b64_tr_b16 v[80:81], v34 offset:2592
  v_mfma_f32_32x32x16_bf16 v[176:191], v[96:99], v[124:127], v[176:191]
  ds_read_b64_tr_b16 v[82:83], v34 offset:2560
  ds_read_b64_tr_b16 v[88:89], v34 offset:3616
  v_mfma_f32_32x32x16_bf16 v[144:159], v[104:107], v[100:103], v[144:159]
  ds_read_b64_tr_b16 v[90:91], v34 offset:3584
  ds_read_b128 v[68:71], v35 offset:96
  v_mfma_f32_32x32x16_bf16 v[160:175], v[104:107], v[108:111], v[160:175]
  ds_read_b128 v[76:79], v35 offset:352
  v_mfma_f32_32x32x16_bf16 v[176:191], v[104:107], v[116:119], v[176:191]
  ds_read_b128 v[84:87], v35 offset:608
  ds_read_b128 v[92:95], v35 offset:864
  v_mfma_f32_32x32x16_bf16 v[160:175], v[112:115], v[100:103], v[160:175]
  ds_write_b32 v15, v19 offset:144
  v_mfma_f32_32x32x16_bf16 v[176:191], v[112:115], v[108:111], v[176:191]
  v_mfma_f32_32x32x16_bf16 v[176:191], v[120:123], v[100:103], v[176:191]
  s_waitcnt lgkmcnt(1)
  v_mfma_f32_32x32x16_bf16 v[128:143], v[64:67], v[68:71], v[128:143]
  ds_read_b64_tr_b16 v[192:193], v34 offset:928
  ds_read_b64_tr_b16 v[194:195], v34 offset:896
  ds_read_b64_tr_b16 v[200:201], v34 offset:1952
  v_mfma_f32_32x32x16_bf16 v[144:159], v[64:67], v[76:79], v[144:159]
  ds_read_b64_tr_b16 v[202:203], v34 offset:1920
  ds_read_b64_tr_b16 v[208:209], v34 offset:2976
  ds_read_b64_tr_b16 v[210:211], v34 offset:2944
  v_mfma_f32_32x32x16_bf16 v[160:175], v[64:67], v[84:87], v[160:175]
  ds_read_b64_tr_b16 v[216:217], v34 offset:4000
  ds_read_b64_tr_b16 v[218:219], v34 offset:3968
  ds_read_b64_tr_b16 v[96:97], v34 offset:672
  v_mfma_f32_32x32x16_bf16 v[176:191], v[64:67], v[92:95], v[176:191]
  ds_read_b64_tr_b16 v[98:99], v34 offset:640
  ds_read_b64_tr_b16 v[104:105], v34 offset:1696
  v_mfma_f32_32x32x16_bf16 v[144:159], v[72:75], v[68:71], v[144:159]
  ds_read_b64_tr_b16 v[106:107], v34 offset:1664
  ds_read_b64_tr_b16 v[112:113], v34 offset:2720
  ds_read_b64_tr_b16 v[114:115], v34 offset:2688
  v_mfma_f32_32x32x16_bf16 v[160:175], v[72:75], v[76:79], v[160:175]
  ds_read_b64_tr_b16 v[120:121], v34 offset:3744
  ds_read_b64_tr_b16 v[122:123], v34 offset:3712
  ds_read_b128 v[100:103], v35 offset:64
  v_mfma_f32_32x32x16_bf16 v[176:191], v[72:75], v[84:87], v[176:191]
  ds_read_b128 v[108:111], v35 offset:320
  ds_read_b128 v[116:119], v35 offset:576
  ds_read_b128 v[124:127], v35 offset:832
  v_mfma_f32_32x32x16_bf16 v[160:175], v[80:83], v[68:71], v[160:175]
  v_mfma_f32_32x32x16_bf16 v[176:191], v[80:83], v[76:79], v[176:191]
  v_mfma_f32_32x32x16_bf16 v[176:191], v[88:91], v[68:71], v[176:191]
  s_waitcnt lgkmcnt(0)
  v_mfma_f32_32x32x16_bf16 v[128:143], v[96:99], v[100:103], v[128:143]
  ds_read_b128 v[196:199], v35 offset:0
  ds_read_b128 v[204:207], v35 offset:256
  v_mfma_f32_32x32x16_bf16 v[144:159], v[96:99], v[108:111], v[144:159]
  ds_read_b128 v[212:215], v35 offset:512
  ds_read_b128 v[220:223], v35 offset:768
  ds_read_b64_tr_b16 v[64:65], v34 offset:800
  v_mfma_f32_32x32x16_bf16 v[160:175], v[96:99], v[116:119], v[160:175]
  ds_read_b64_tr_b16 v[66:67], v34 offset:768
  ds_read_b64_tr_b16 v[72:73], v34 offset:1824
  v_mfma_f32_32x32x16_bf16 v[176:191], v[96:99], v[124:127], v[176:191]
  ds_read_b64_tr_b16 v[74:75], v34 offset:1792
  ds_read_b64_tr_b16 v[80:81], v34 offset:2848
  v_mfma_f32_32x32x16_bf16 v[144:159], v[104:107], v[100:103], v[144:159]
  ds_read_b64_tr_b16 v[82:83], v34 offset:2816
  ds_read_b64_tr_b16 v[88:89], v34 offset:3872
  v_mfma_f32_32x32x16_bf16 v[160:175], v[104:107], v[108:111], v[160:175]
  ds_read_b64_tr_b16 v[90:91], v34 offset:3840
  ds_read_b128 v[68:71], v35 offset:32
  ds_read_b128 v[76:79], v35 offset:288
  v_mfma_f32_32x32x16_bf16 v[176:191], v[104:107], v[116:119], v[176:191]
  ds_read_b128 v[84:87], v35 offset:544
  ds_read_b128 v[92:95], v35 offset:800
  v_mfma_f32_32x32x16_bf16 v[160:175], v[112:115], v[100:103], v[160:175]
  v_mfma_f32_32x32x16_bf16 v[176:191], v[112:115], v[108:111], v[176:191]
  v_mfma_f32_32x32x16_bf16 v[176:191], v[120:123], v[100:103], v[176:191]
  s_waitcnt lgkmcnt(0)
  v_mfma_f32_32x32x16_bf16 v[128:143], v[64:67], v[68:71], v[128:143]
  v_mfma_f32_32x32x16_bf16 v[128:143], v[192:195], v[196:199], v[128:143]
  v_mfma_f32_32x32x16_bf16 v[144:159], v[64:67], v[76:79], v[144:159]
  v_mfma_f32_32x32x16_bf16 v[144:159], v[72:75], v[68:71], v[144:159]
  s_nop 9
  v_cvt_pk_f16_f32 v128, v128, v129
  v_cvt_pk_f16_f32 v136, v136, v137
  v_cvt_pk_f16_f32 v130, v130, v131
  v_cvt_pk_f16_f32 v138, v138, v139
  v_cvt_pk_f16_f32 v132, v132, v133
  v_mfma_f32_32x32x16_bf16 v[144:159], v[192:195], v[204:207], v[144:159]
  v_cvt_pk_f16_f32 v140, v140, v141
  v_cvt_pk_f16_f32 v134, v134, v135
  v_cvt_pk_f16_f32 v142, v142, v143
  v_permlane16_swap_b32 v128, v136
  v_mfma_f32_32x32x16_bf16 v[144:159], v[200:203], v[196:199], v[144:159]
  v_permlane16_swap_b32 v130, v138
  v_permlane16_swap_b32 v132, v140
  v_mfma_f32_32x32x16_bf16 v[160:175], v[64:67], v[84:87], v[160:175]
  v_permlane16_swap_b32 v134, v142
  ds_write_b32 v40, v142 offset:0
  v_mfma_f32_32x32x16_bf16 v[160:175], v[72:75], v[76:79], v[160:175]
  v_pk_add_f16 v129, v130, v136
  v_pk_add_f16 v130, v132, v138
  v_pk_add_f16 v131, v134, v140
  v_mfma_f32_32x32x16_bf16 v[160:175], v[80:83], v[68:71], v[160:175]
  ds_write_b128 v39, v[128:131] offset:0
  s_nop 0
  v_cvt_pk_f16_f32 v144, v144, v145
  v_cvt_pk_f16_f32 v152, v152, v153
  v_mfma_f32_32x32x16_bf16 v[160:175], v[192:195], v[212:215], v[160:175]
  v_cvt_pk_f16_f32 v146, v146, v147
  v_cvt_pk_f16_f32 v154, v154, v155
  v_cvt_pk_f16_f32 v148, v148, v149
  v_cvt_pk_f16_f32 v156, v156, v157
  v_cvt_pk_f16_f32 v150, v150, v151
  v_mfma_f32_32x32x16_bf16 v[160:175], v[200:203], v[204:207], v[160:175]
  v_cvt_pk_f16_f32 v158, v158, v159
  v_permlane16_swap_b32 v144, v152
  v_permlane16_swap_b32 v146, v154
  v_mfma_f32_32x32x16_bf16 v[160:175], v[208:211], v[196:199], v[160:175]
  v_permlane16_swap_b32 v148, v156
  v_permlane16_swap_b32 v150, v158
  v_mfma_f32_32x32x16_bf16 v[176:191], v[64:67], v[92:95], v[176:191]
  ds_write_b32 v40, v158 offset:1280
  v_pk_add_f16 v145, v146, v152
  v_pk_add_f16 v146, v148, v154
  v_mfma_f32_32x32x16_bf16 v[176:191], v[72:75], v[84:87], v[176:191]
  v_pk_add_f16 v147, v150, v156
  ds_write_b128 v39, v[144:147] offset:1280
  v_mfma_f32_32x32x16_bf16 v[176:191], v[80:83], v[76:79], v[176:191]
  s_nop 1
  v_cvt_pk_f16_f32 v160, v160, v161
  v_cvt_pk_f16_f32 v168, v168, v169
  v_cvt_pk_f16_f32 v162, v162, v163
  v_cvt_pk_f16_f32 v170, v170, v171
  v_cvt_pk_f16_f32 v164, v164, v165
  v_mfma_f32_32x32x16_bf16 v[176:191], v[88:91], v[68:71], v[176:191]
  v_cvt_pk_f16_f32 v172, v172, v173
  v_cvt_pk_f16_f32 v166, v166, v167
  v_cvt_pk_f16_f32 v174, v174, v175
  v_permlane16_swap_b32 v160, v168
  v_mfma_f32_32x32x16_bf16 v[176:191], v[192:195], v[220:223], v[176:191]
  v_permlane16_swap_b32 v162, v170
  v_permlane16_swap_b32 v164, v172
  v_mfma_f32_32x32x16_bf16 v[176:191], v[200:203], v[212:215], v[176:191]
  v_permlane16_swap_b32 v166, v174
  ds_write_b32 v40, v174 offset:2560
  v_mfma_f32_32x32x16_bf16 v[176:191], v[208:211], v[204:207], v[176:191]
  v_pk_add_f16 v161, v162, v168
  v_pk_add_f16 v162, v164, v170
  v_pk_add_f16 v163, v166, v172
  v_mfma_f32_32x32x16_bf16 v[176:191], v[216:219], v[196:199], v[176:191]
  ds_write_b128 v39, v[160:163] offset:2560
  s_setprio 2
  s_waitcnt vmcnt(0)
  ds_write_b32 v15, v19 offset:0
  s_nop 7
  v_cvt_pk_f16_f32 v176, v176, v177
  v_cvt_pk_f16_f32 v184, v184, v185
  v_cvt_pk_f16_f32 v178, v178, v179
  v_cvt_pk_f16_f32 v186, v186, v187
  v_cvt_pk_f16_f32 v180, v180, v181
  v_cvt_pk_f16_f32 v188, v188, v189
  v_cvt_pk_f16_f32 v182, v182, v183
  v_cvt_pk_f16_f32 v190, v190, v191
  v_permlane16_swap_b32 v176, v184
  v_permlane16_swap_b32 v178, v186
  v_permlane16_swap_b32 v180, v188
  v_permlane16_swap_b32 v182, v190
  ds_write_b32 v40, v190 offset:3840
  v_pk_add_f16 v177, v178, v184
  v_pk_add_f16 v178, v180, v186
  v_pk_add_f16 v179, v182, v188
  ds_write_b128 v39, v[176:179] offset:3840
  ds_write_b32 v15, v19 offset:64
  s_mov_b32 s85, 0
L_rt_ly:
  ds_read_b32 v17, v48 offset:64
  ds_read_b32 v4, v42 offset:64
  ds_read_b128 v[192:195], v41 offset:0
  ds_read_b32 v5, v42 offset:11984
  ds_read_b128 v[196:199], v41 offset:11920
  ds_read_b32 v6, v42 offset:1344
  ds_read_b128 v[200:203], v41 offset:1280
  ds_read_b32 v7, v42 offset:13264
  ds_read_b128 v[204:207], v41 offset:13200
  s_waitcnt lgkmcnt(8)
  v_cmp_eq_u32 vcc, 0, v17
  s_nop 0
  s_cbranch_vccz L_ok_ly
  s_sleep 1
  s_add_u32 s85, s85, 1
  s_cmp_lt_u32 s85, 0x400000
  s_cbranch_scc1 L_rt_ly
L_ok_ly:
  ds_write_b32 v15, v19 offset:80
  ds_read_b32 v17, v16 offset:0
  s_waitcnt lgkmcnt(6)
  v_pk_add_f16 v4, v4, v5
  v_pk_add_f16 v192, v192, v196
  v_pk_add_f16 v193, v193, v197
  v_pk_add_f16 v194, v194, v198
  v_pk_add_f16 v195, v195, v199
  v_pk_add_f16 v192, v192, v4
  v_bfi_b32 v192, s61, v20, v192
  v_bfi_b32 v193, s61, v21, v193
  v_bfi_b32 v194, s61, v22, v194
  v_bfi_b32 v195, s61, v23, v195
  buffer_store_dwordx4 v[192:195], v18, s[36:39], s63 offen offset:0 sc1
  s_waitcnt lgkmcnt(2)
  s_waitcnt lgkmcnt(0)
  v_cmp_eq_u32 vcc, 0, v17
  s_nop 0
  s_cbranch_vccnz L_spin_lwb
L_ok_lwb:
  s_load_dwordx8 s[12:19], s[36:37], s62 glc
  v_pk_add_f16 v6, v6, v7
  v_pk_add_f16 v200, v200, v204
  v_pk_add_f16 v201, v201, v205
  v_pk_add_f16 v202, v202, v206
  v_pk_add_f16 v203, v203, v207
  v_pk_add_f16 v200, v200, v6
  v_bfi_b32 v200, s61, v20, v200
  v_bfi_b32 v201, s61, v21, v201
  v_bfi_b32 v202, s61, v22, v202
  v_bfi_b32 v203, s61, v23, v203
  buffer_store_dwordx4 v[200:203], v18, s[36:39], s63 offen offset:1024 sc1
  s_setprio 0
  ds_read_b64_tr_b16 v[64:65], v24 offset:0
  ds_read_b64_tr_b16 v[66:67], v24 offset:1024
  ds_read_b64_tr_b16 v[68:69], v25 offset:0
  ds_read_b64_tr_b16 v[70:71], v25 offset:1024
  ds_read_b64_tr_b16 v[72:73], v24 offset:2048
  ds_read_b64_tr_b16 v[74:75], v24 offset:3072
  ds_read_b64_tr_b16 v[76:77], v25 offset:2048
  ds_read_b64_tr_b16 v[78:79], v25 offset:3072
  ds_read_b64_tr_b16 v[80:81], v24 offset:4096
  ds_read_b64_tr_b16 v[82:83], v24 offset:5120
  ds_read_b64_tr_b16 v[84:85], v25 offset:4096
  ds_read_b64_tr_b16 v[86:87], v25 offset:5120
  ds_read_b64_tr_b16 v[88:89], v24 offset:6144
  ds_read_b64_tr_b16 v[90:91], v24 offset:7168
  ds_read_b64_tr_b16 v[92:93], v25 offset:6144
  ds_read_b64_tr_b16 v[94:95], v25 offset:7168
  s_mov_b32 s85, 0
  s_branch L_c_ph1
L_rt_ph1:
  s_sleep 1
  s_add_u32 s85, s85, 1
  s_cmp_gt_u32 s85, 0x40000
  s_cbranch_scc1 L_ok_ph1
  s_load_dwordx8 s[12:19], s[36:37], s62 glc
L_c_ph1:
  s_waitcnt lgkmcnt(0)
  s_cmp_lg_u64 s[12:13], s[82:83]
  s_cbranch_scc1 L_rt_ph1
  s_cmp_lg_u64 s[14:15], s[82:83]
  s_cbranch_scc1 L_rt_ph1
  s_cmp_lg_u64 s[16:17], s[82:83]
  s_cbranch_scc1 L_rt_ph1
  s_cmp_lg_u32 s18, s82
  s_cbranch_scc1 L_rt_ph1
L_ok_ph1:
  s_mov_b32 s85, 0
L_rt_lha:
  ds_read_b32 v17, v16 offset:208
  s_waitcnt lgkmcnt(0)
  v_cmp_eq_u32 vcc, 0, v17
  s_nop 0
  s_cbranch_vccz L_ok_lha
  s_sleep 1
  s_add_u32 s85, s85, 1
  s_cmp_lt_u32 s85, 0x400000
  s_cbranch_scc1 L_rt_lha
L_ok_lha:
  buffer_load_dwordx4 v[224:227], v44, s[36:39], s91 offen offset:0 sc1
  buffer_load_dwordx4 v[228:231], v44, s[36:39], s91 offen offset:1024 sc1
  buffer_load_dwordx4 v[232:235], v44, s[36:39], s91 offen offset:2048 sc1
  buffer_load_dwordx4 v[236:239], v44, s[36:39], s91 offen offset:3072 sc1
  buffer_load_dwordx4 v[240:243], v44, s[36:39], s92 offen offset:0 sc1
  buffer_load_dwordx4 v[244:247], v44, s[36:39], s92 offen offset:1024 sc1
  buffer_load_dwordx4 v[248:251], v44, s[36:39], s92 offen offset:2048 sc1
  buffer_load_dwordx4 v[252:255], v44, s[36:39], s92 offen offset:3072 sc1
  buffer_load_dwordx4 v[112:115], v44, s[36:39], s93 offen offset:0 sc1
  buffer_load_dwordx4 v[116:119], v44, s[36:39], s93 offen offset:1024 sc1
  buffer_load_dwordx4 v[120:123], v44, s[36:39], s93 offen offset:2048 sc1
  buffer_load_dwordx4 v[124:127], v44, s[36:39], s93 offen offset:3072 sc1
  s_setprio 1
  s_waitcnt vmcnt(11)
  v_mfma_f32_32x32x16_bf16 v[128:143], v[64:67], v[224:227], 0
  buffer_load_dwordx4 v[160:163], v44, s[36:39], s94 offen offset:0 sc1
  ds_read_b64_tr_b16 v[96:97], v24 offset:16384
  ds_read_b64_tr_b16 v[98:99], v24 offset:17408
  v_mfma_f32_32x32x16_bf16 v[144:159], v[68:71], v[224:227], 0
  buffer_load_dwordx4 v[164:167], v44, s[36:39], s94 offen offset:1024 sc1
  ds_read_b64_tr_b16 v[100:101], v25 offset:16384
  ds_read_b64_tr_b16 v[102:103], v25 offset:17408
  s_waitcnt vmcnt(12)
  v_mfma_f32_32x32x16_bf16 v[128:143], v[72:75], v[228:231], v[128:143]
  buffer_load_dwordx4 v[168:171], v44, s[36:39], s94 offen offset:2048 sc1
  ds_read_b64_tr_b16 v[104:105], v24 offset:18432
  ds_read_b64_tr_b16 v[106:107], v24 offset:19456
  v_mfma_f32_32x32x16_bf16 v[144:159], v[76:79], v[228:231], v[144:159]
  buffer_load_dwordx4 v[172:175], v44, s[36:39], s94 offen offset:3072 sc1
  ds_read_b64_tr_b16 v[108:109], v25 offset:18432
  ds_read_b64_tr_b16 v[110:111], v25 offset:19456
  s_waitcnt vmcnt(13)
  v_mfma_f32_32x32x16_bf16 v[128:143], v[80:83], v[232:235], v[128:143]
  buffer_load_dwordx4 v[176:179], v44, s[36:39], s95 offen offset:0 sc1
  ds_read_b64_tr_b16 v[64:65], v24 offset:20480
  ds_read_b64_tr_b16 v[66:67], v24 offset:21504
  v_mfma_f32_32x32x16_bf16 v[144:159], v[84:87], v[232:235], v[144:159]
  buffer_load_dwordx4 v[180:183], v44, s[36:39], s95 offen offset:1024 sc1
  ds_read_b64_tr_b16 v[68:69], v25 offset:20480
  ds_read_b64_tr_b16 v[70:71], v25 offset:21504
  s_waitcnt vmcnt(14)
  v_mfma_f32_32x32x16_bf16 v[128:143], v[88:91], v[236:239], v[128:143]
  buffer_load_dwordx4 v[184:187], v44, s[36:39], s95 offen offset:2048 sc1
  ds_read_b64_tr_b16 v[72:73], v24 offset:22528
  ds_read_b64_tr_b16 v[74:75], v24 offset:23552
  v_mfma_f32_32x32x16_bf16 v[144:159], v[92:95], v[236:239], v[144:159]
  buffer_load_dwordx4 v[188:191], v44, s[36:39], s95 offen offset:3072 sc1
  ds_read_b64_tr_b16 v[76:77], v25 offset:22528
  ds_read_b64_tr_b16 v[78:79], v25 offset:23552
  s_waitcnt vmcnt(15)
  s_waitcnt lgkmcnt(14)
  v_mfma_f32_32x32x16_bf16 v[128:143], v[96:99], v[240:243], v[128:143]
  buffer_load_dwordx4 v[192:195], v44, s[36:39], s96 offen offset:0 sc1
  ds_read_b64_tr_b16 v[80:81], v24 offset:32768
  ds_read_b64_tr_b16 v[82:83], v24 offset:33792
  s_waitcnt lgkmcnt(14)
  v_mfma_f32_32x32x16_bf16 v[144:159], v[100:103], v[240:243], v[144:159]
  buffer_load_dwordx4 v[196:199], v44, s[36:39], s96 offen offset:1024 sc1
  ds_read_b64_tr_b16 v[84:85], v25 offset:32768
  ds_read_b64_tr_b16 v[86:87], v25 offset:33792
  s_waitcnt vmcnt(16)
  s_waitcnt lgkmcnt(14)
  v_mfma_f32_32x32x16_bf16 v[128:143], v[104:107], v[244:247], v[128:143]
  buffer_load_dwordx4 v[200:203], v44, s[36:39], s96 offen offset:2048 sc1
  ds_read_b64_tr_b16 v[88:89], v24 offset:34816
  ds_read_b64_tr_b16 v[90:91], v24 offset:35840
  s_waitcnt lgkmcnt(14)
  v_mfma_f32_32x32x16_bf16 v[144:159], v[108:111], v[244:247], v[144:159]
  buffer_load_dwordx4 v[204:207], v44, s[36:39], s96 offen offset:3072 sc1
  ds_write_b32 v15, v19 offset:160
  ds_read_b64_tr_b16 v[92:93], v25 offset:34816
  ds_read_b64_tr_b16 v[94:95], v25 offset:35840
  s_waitcnt vmcnt(17)
  s_waitcnt lgkmcnt(15)
  v_mfma_f32_32x32x16_bf16 v[128:143], v[64:67], v[248:251], v[128:143]
  ds_read_b64_tr_b16 v[96:97], v24 offset:36864
  ds_read_b64_tr_b16 v[98:99], v24 offset:37888
  s_waitcnt lgkmcnt(15)
  v_mfma_f32_32x32x16_bf16 v[144:159], v[68:71], v[248:251], v[144:159]
  ds_read_b64_tr_b16 v[100:101], v25 offset:36864
  ds_read_b64_tr_b16 v[102:103], v25 offset:37888
  s_waitcnt vmcnt(16)
  s_waitcnt lgkmcnt(15)
  v_mfma_f32_32x32x16_bf16 v[128:143], v[72:75], v[252:255], v[128:143]
  ds_read_b64_tr_b16 v[104:105], v24 offset:38912
  ds_read_b64_tr_b16 v[106:107], v24 offset:39936
  s_waitcnt lgkmcnt(15)
  v_mfma_f32_32x32x16_bf16 v[144:159], v[76:79], v[252:255], v[144:159]
  ds_read_b64_tr_b16 v[108:109], v25 offset:38912
  ds_read_b64_tr_b16 v[110:111], v25 offset:39936
  s_waitcnt vmcnt(15)
  s_waitcnt lgkmcnt(15)
  v_mfma_f32_32x32x16_bf16 v[128:143], v[80:83], v[112:115], v[128:143]
  ds_read_b64_tr_b16 v[64:65], v24 offset:49152
  ds_read_b64_tr_b16 v[66:67], v24 offset:50176
  s_waitcnt lgkmcnt(15)
  v_mfma_f32_32x32x16_bf16 v[144:159], v[84:87], v[112:115], v[144:159]
  ds_read_b64_tr_b16 v[68:69], v25 offset:49152
  ds_read_b64_tr_b16 v[70:71], v25 offset:50176
  s_waitcnt vmcnt(14)
  s_waitcnt lgkmcnt(15)
  v_mfma_f32_32x32x16_bf16 v[128:143], v[88:91], v[116:119], v[128:143]
  ds_read_b64_tr_b16 v[72:73], v24 offset:51200
  ds_read_b64_tr_b16 v[74:75], v24 offset:52224
  s_waitcnt lgkmcnt(14)
  v_mfma_f32_32x32x16_bf16 v[144:159], v[92:95], v[116:119], v[144:159]
  ds_read_b64_tr_b16 v[76:77], v25 offset:51200
  ds_read_b64_tr_b16 v[78:79], v25 offset:52224
  s_waitcnt vmcnt(13)
  s_waitcnt lgkmcnt(14)
  v_mfma_f32_32x32x16_bf16 v[128:143], v[96:99], v[120:123], v[128:143]
  ds_read_b32 v17, v48 offset:80
  s_waitcnt lgkmcnt(0)
  v_cmp_eq_u32 vcc, 0, v17
  s_nop 0
  s_cbranch_vccnz L_spin_lyb
L_ok_lyb:
  ds_read_b64_tr_b16 v[80:81], v24 offset:53248
  ds_read_b64_tr_b16 v[82:83], v24 offset:54272
  v_mfma_f32_32x32x16_bf16 v[144:159], v[100:103], v[120:123], v[144:159]
  ds_read_b64_tr_b16 v[84:85], v25 offset:53248
  ds_read_b64_tr_b16 v[86:87], v25 offset:54272
  s_waitcnt vmcnt(12)
  v_mfma_f32_32x32x16_bf16 v[128:143], v[104:107], v[124:127], v[128:143]
  ds_read_b64_tr_b16 v[88:89], v24 offset:55296
  ds_read_b64_tr_b16 v[90:91], v24 offset:56320
  v_mfma_f32_32x32x16_bf16 v[144:159], v[108:111], v[124:127], v[144:159]
  ds_read_b64_tr_b16 v[92:93], v25 offset:55296
  ds_read_b64_tr_b16 v[94:95], v25 offset:56320
  s_waitcnt vmcnt(11)
  v_mfma_f32_32x32x16_bf16 v[128:143], v[64:67], v[160:163], v[128:143]
  ds_read_b64_tr_b16 v[96:97], v26 offset:0
  ds_read_b64_tr_b16 v[98:99], v26 offset:1024
  v_mfma_f32_32x32x16_bf16 v[144:159], v[68:71], v[160:163], v[144:159]
  ds_read_b64_tr_b16 v[100:101], v26 offset:2048
  ds_read_b64_tr_b16 v[102:103], v26 offset:3072
  s_waitcnt vmcnt(10)
  v_mfma_f32_32x32x16_bf16 v[128:143], v[72:75], v[164:167], v[128:143]
  ds_read_b64_tr_b16 v[104:105], v26 offset:4096
  ds_read_b64_tr_b16 v[106:107], v26 offset:5120
  v_mfma_f32_32x32x16_bf16 v[144:159], v[76:79], v[164:167], v[144:159]
  ds_read_b64_tr_b16 v[108:109], v26 offset:6144
  ds_read_b64_tr_b16 v[110:111], v26 offset:7168
  s_waitcnt vmcnt(9)
  s_waitcnt lgkmcnt(14)
  v_mfma_f32_32x32x16_bf16 v[128:143], v[80:83], v[168:171], v[128:143]
  ds_read_b64_tr_b16 v[64:65], v26 offset:16384
  ds_read_b64_tr_b16 v[66:67], v26 offset:17408
  s_waitcnt lgkmcnt(14)
  v_mfma_f32_32x32x16_bf16 v[144:159], v[84:87], v[168:171], v[144:159]
  ds_read_b64_tr_b16 v[68:69], v26 offset:18432
  ds_read_b64_tr_b16 v[70:71], v26 offset:19456
  s_waitcnt vmcnt(8)
  s_waitcnt lgkmcnt(14)
  v_mfma_f32_32x32x16_bf16 v[128:143], v[88:91], v[172:175], v[128:143]
  ds_read_b64_tr_b16 v[72:73], v26 offset:20480
  ds_read_b64_tr_b16 v[74:75], v26 offset:21504
  s_waitcnt lgkmcnt(14)
  v_mfma_f32_32x32x16_bf16 v[144:159], v[92:95], v[172:175], v[144:159]
  ds_read_b64_tr_b16 v[76:77], v26 offset:22528
  ds_read_b64_tr_b16 v[78:79], v26 offset:23552
  s_waitcnt vmcnt(7)
  s_waitcnt lgkmcnt(14)
  v_mfma_f32_32x32x16_bf16 v[128:143], v[96:99], v[176:179], v[128:143]
  ds_read_b64_tr_b16 v[80:81], v27 offset:0
  ds_read_b64_tr_b16 v[82:83], v27 offset:1024
  s_waitcnt vmcnt(6)
  s_waitcnt lgkmcnt(14)
  v_mfma_f32_32x32x16_bf16 v[128:143], v[100:103], v[180:183], v[128:143]
  ds_read_b64_tr_b16 v[84:85], v27 offset:2048
  ds_read_b64_tr_b16 v[86:87], v27 offset:3072
  s_waitcnt vmcnt(5)
  s_waitcnt lgkmcnt(14)
  v_mfma_f32_32x32x16_bf16 v[128:143], v[104:107], v[184:187], v[128:143]
  ds_read_b64_tr_b16 v[88:89], v27 offset:4096
  ds_read_b64_tr_b16 v[90:91], v27 offset:5120
  s_waitcnt vmcnt(4)
  s_waitcnt lgkmcnt(14)
  v_mfma_f32_32x32x16_bf16 v[128:143], v[108:111], v[188:191], v[128:143]
  ds_read_b64_tr_b16 v[92:93], v27 offset:6144
  ds_read_b64_tr_b16 v[94:95], v27 offset:7168
  s_waitcnt vmcnt(3)
  s_waitcnt lgkmcnt(14)
  v_mfma_f32_32x32x16_bf16 v[128:143], v[64:67], v[192:195], v[128:143]
  buffer_load_dwordx4 v[240:243], v18, s[36:39], s60 offen offset:0 sc1
  buffer_load_dwordx4 v[244:247], v18, s[36:39], s60 offen offset:1024 sc1
  ds_read_b64_tr_b16 v[96:97], v27 offset:16384
  ds_read_b64_tr_b16 v[98:99], v27 offset:17408
  s_waitcnt vmcnt(4)
  s_waitcnt lgkmcnt(14)
  v_mfma_f32_32x32x16_bf16 v[128:143], v[68:71], v[196:199], v[128:143]
  ds_read_b64_tr_b16 v[100:101], v27 offset:18432
  ds_read_b64_tr_b16 v[102:103], v27 offset:19456
  s_waitcnt vmcnt(3)
  s_waitcnt lgkmcnt(14)
  v_mfma_f32_32x32x16_bf16 v[128:143], v[72:75], v[200:203], v[128:143]
  ds_read_b64_tr_b16 v[104:105], v27 offset:20480
  ds_read_b64_tr_b16 v[106:107], v27 offset:21504
  s_waitcnt vmcnt(2)
  s_waitcnt lgkmcnt(14)
  v_mfma_f32_32x32x16_bf16 v[128:143], v[76:79], v[204:207], v[128:143]
  ds_read_b64_tr_b16 v[108:109], v27 offset:22528
  ds_read_b64_tr_b16 v[110:111], v27 offset:23552
  s_waitcnt lgkmcnt(14)
  v_mfma_f32_32x32x16_bf16 v[144:159], v[80:83], v[176:179], v[144:159]
  s_waitcnt lgkmcnt(12)
  v_mfma_f32_32x32x16_bf16 v[144:159], v[84:87], v[180:183], v[144:159]
  s_nop 5
  ds_write_b128 v46, v[128:131] offset:6720
  ds_write_b128 v46, v[132:135] offset:7744
  s_waitcnt lgkmcnt(12)
  v_mfma_f32_32x32x16_bf16 v[144:159], v[88:91], v[184:187], v[144:159]
  ds_write_b128 v46, v[136:139] offset:8768
  ds_write_b128 v46, v[140:143] offset:9792
  ds_write_b32 v15, v19 offset:96
  ds_read_b32 v17, v15 offset:112
  ds_read_b32 v4, v51 offset:6144
  ds_read_b128 v[224:227], v46 offset:0
  s_waitcnt lgkmcnt(15)
  v_mfma_f32_32x32x16_bf16 v[144:159], v[92:95], v[188:191], v[144:159]
  ds_read_b128 v[228:231], v46 offset:1024
  ds_read_b128 v[232:235], v46 offset:2048
  ds_read_b128 v[236:239], v46 offset:3072
  s_waitcnt lgkmcnt(5)
  v_mfma_f32_32x32x16_bf16 v[144:159], v[96:99], v[192:195], v[144:159]
  v_cmp_eq_u32 vcc, 0, v17
  s_nop 0
  s_cbranch_vccnz L_spin_le
L_ok_le:
  ds_read_b32 v17, v48 offset:96
  ds_read_b128 v[128:131], v47 offset:6720
  ds_read_b128 v[132:135], v47 offset:7744
  ds_read_b128 v[136:139], v47 offset:8768
  ds_read_b128 v[140:143], v47 offset:9792
  v_mfma_f32_32x32x16_bf16 v[144:159], v[100:103], v[196:199], v[144:159]
  s_waitcnt lgkmcnt(4)
  v_cmp_eq_u32 vcc, 0, v17
  s_nop 0
  s_cbranch_vccnz L_spin_lx
L_ok_lx:
  v_mfma_f32_32x32x16_bf16 v[144:159], v[104:107], v[200:203], v[144:159]
  s_waitcnt lgkmcnt(0)
  v_fmac_f32 v224, v128, v4
  v_fmac_f32 v225, v129, v4
  v_fmac_f32 v226, v130, v4
  v_fmac_f32 v227, v131, v4
  v_mfma_f32_32x32x16_bf16 v[144:159], v[108:111], v[204:207], v[144:159]
  v_fmac_f32 v228, v132, v4
L_stub1:
  s_cbranch_execz L_stub2
  v_fmac_f32 v229, v133, v4
  v_fmac_f32 v230, v134, v4
  v_fmac_f32 v231, v135, v4
  v_fmac_f32 v232, v136, v4
  v_fmac_f32 v233, v137, v4
  v_fmac_f32 v234, v138, v4
  v_fmac_f32 v235, v139, v4
  v_fmac_f32 v236, v140, v4
  v_fmac_f32 v237, v141, v4
  v_fmac_f32 v238, v142, v4
  v_fmac_f32 v239, v143, v4
  s_waitcnt vmcnt(0)
  v_xor_b32 v240, v20, v240
  v_xor_b32 v241, v21, v241
  v_xor_b32 v242, v22, v242
  v_xor_b32 v243, v23, v243
  v_xor_b32 v244, v20, v244
  v_xor_b32 v245, v21, v245
  v_xor_b32 v246, v22, v246
  v_xor_b32 v247, v23, v247
  v_or_b32 v12, v240, v241
  v_or3_b32 v12, v12, v242, v243
  v_or3_b32 v12, v12, v244, v245
  v_or3_b32 v12, v12, v246, v247
  v_and_b32 v12, s61, v12
  v_cmp_ne_u32 vcc, 0, v12
  s_nop 0
  s_cbranch_vccnz L_spin_pp
L_ok_pp:
  v_fma_mix_f32 v224, v240, v4, v224 op_sel:[0,0,0] op_sel_hi:[1,0,0]
  v_fma_mix_f32 v225, v240, v4, v225 op_sel:[1,0,0] op_sel_hi:[1,0,0]
  v_fma_mix_f32 v226, v241, v4, v226 op_sel:[0,0,0] op_sel_hi:[1,0,0]
  v_fma_mix_f32 v227, v241, v4, v227 op_sel:[1,0,0] op_sel_hi:[1,0,0]
  v_fma_mix_f32 v228, v242, v4, v228 op_sel:[0,0,0] op_sel_hi:[1,0,0]
  v_fma_mix_f32 v229, v242, v4, v229 op_sel:[1,0,0] op_sel_hi:[1,0,0]
  v_fma_mix_f32 v230, v243, v4, v230 op_sel:[0,0,0] op_sel_hi:[1,0,0]
  v_fma_mix_f32 v231, v243, v4, v231 op_sel:[1,0,0] op_sel_hi:[1,0,0]
  v_fma_mix_f32 v232, v244, v4, v232 op_sel:[0,0,0] op_sel_hi:[1,0,0]
  v_fma_mix_f32 v233, v244, v4, v233 op_sel:[1,0,0] op_sel_hi:[1,0,0]
  v_fma_mix_f32 v234, v245, v4, v234 op_sel:[0,0,0] op_sel_hi:[1,0,0]
  v_fma_mix_f32 v235, v245, v4, v235 op_sel:[1,0,0] op_sel_hi:[1,0,0]
  v_fma_mix_f32 v236, v246, v4, v236 op_sel:[0,0,0] op_sel_hi:[1,0,0]
  v_fma_mix_f32 v237, v246, v4, v237 op_sel:[1,0,0] op_sel_hi:[1,0,0]
  v_fma_mix_f32 v238, v247, v4, v238 op_sel:[0,0,0] op_sel_hi:[1,0,0]
  v_fma_mix_f32 v239, v247, v4, v239 op_sel:[1,0,0] op_sel_hi:[1,0,0]
  v_pk_fma_f32 v[224:225], v[144:145], v[4:5], v[224:225] op_sel_hi:[1,0,1]
  v_pk_fma_f32 v[226:227], v[146:147], v[4:5], v[226:227] op_sel_hi:[1,0,1]
  v_pk_fma_f32 v[228:229], v[148:149], v[4:5], v[228:229] op_sel_hi:[1,0,1]
  v_pk_fma_f32 v[230:231], v[150:151], v[4:5], v[230:231] op_sel_hi:[1,0,1]
  v_cvt_pk_bf16_f32 v240, v224, v225
  v_cvt_pk_bf16_f32 v241, v226, v227
  v_cvt_pk_bf16_f32 v242, v228, v229
  v_cvt_pk_bf16_f32 v243, v230, v231
  ds_write_b128 v49, v[240:243] offset:0
  v_pk_fma_f32 v[232:233], v[152:153], v[4:5], v[232:233] op_sel_hi:[1,0,1]
  v_pk_fma_f32 v[234:235], v[154:155], v[4:5], v[234:235] op_sel_hi:[1,0,1]
  v_pk_fma_f32 v[236:237], v[156:157], v[4:5], v[236:237] op_sel_hi:[1,0,1]
  v_pk_fma_f32 v[238:239], v[158:159], v[4:5], v[238:239] op_sel_hi:[1,0,1]
  v_cvt_pk_bf16_f32 v244, v232, v233
  v_cvt_pk_bf16_f32 v245, v234, v235
  v_cvt_pk_bf16_f32 v246, v236, v237
  v_cvt_pk_bf16_f32 v247, v238, v239
  ds_write_b128 v49, v[244:247] offset:32
  ds_read_b128 v[248:251], v50 offset:0
  ds_read_b128 v[252:255], v50 offset:1280
  s_waitcnt lgkmcnt(1)
  buffer_store_dwordx4 v[248:251], v45, s[32:35], 0 offen
  s_waitcnt lgkmcnt(0)
  buffer_store_dwordx4 v[252:255], v45, s[32:35], s56 offen
  s_endpgm
L_A:
  v_and_b32 v160, 7, v1
  v_lshrrev_b32 v161, 3, v1
  v_and_b32 v163, 15, v1
  v_lshrrev_b32 v162, 4, v1
  s_lshl_b32 s78, s70, 7
  s_add_u32 s78, s78, 0x26800
  v_lshl_add_u32 v164, v163, 3, s78
  s_and_b32 s6, s70, 1
  v_and_b32 v28, 31, v1
  v_lshrrev_b32 v29, 5, v1
  s_lshl_b32 s78, s76, 8
  s_lshl_b32 s81, s6, 7
  s_add_u32 s78, s78, s81
  v_bfe_u32 v7, v1, 4, 1
  v_lshl_add_u32 v56, v7, 4, s78
  v_lshl_add_u32 v56, v29, 3, v56
  s_lshl_b32 s78, s74, 7
  s_lshl_b32 s81, s6, 6
  s_add_u32 s78, s78, s81
  v_lshl_add_u32 v57, v29, 4, s78
  v_and_b32 v8, 3, v1
  v_bfe_u32 v9, v1, 2, 2
  v_bfe_u32 v7, v1, 4, 1
  v_mov_b32 v245, 0
  v_mov_b32 v247, 0
  v_lshlrev_b32 v4, 2, v1
  v_add_u32 v4, 0x27f00, v4
  ds_write_b32 v4, v245
  s_waitcnt lgkmcnt(0)
  s_load_dword s82, s[68:69], 0
  s_mov_b64 s[8:9], s[56:57]
  s_mov_b64 s[10:11], s[60:61]
  global_load_dwordx2 v[64:65], v56, s[8:9] offset:0
  global_load_dwordx2 v[66:67], v56, s[8:9] offset:32
  global_load_dwordx2 v[68:69], v56, s[8:9] offset:64
  global_load_dwordx2 v[70:71], v56, s[8:9] offset:96
  global_load_dwordx4 v[48:51], v57, s[10:11] offset:0
  global_load_dwordx4 v[52:55], v57, s[10:11] offset:32
  s_mov_b64 s[36:37], s[68:69]
  s_mov_b32 s38, 0x1200000
  s_mov_b32 s39, 0x20000
  s_lshl_b32 s78, s70, 5
  s_add_u32 s78, s78, 0x20200
  v_lshl_add_u32 v166, v162, 11, s78
  v_lshl_add_u32 v166, v9, 7, v166
  v_lshl_add_u32 v166, v8, 3, v166
  s_mul_i32 s78, s70, 2304
  s_add_u32 s78, s78, 0x24400
  v_mul_u32_u24 v167, 144, v163
  v_lshl_add_u32 v167, v162, 5, v167
  v_add_u32 v167, s78, v167
  v_mul_u32_u24 v168, 144, v161
  v_lshl_add_u32 v168, v160, 4, v168
  v_add_u32 v168, s78, v168
  s_mul_i32 s78, s74, 270336
  s_mul_i32 s81, s70, 67584
  s_add_u32 s78, s78, s81
  s_lshl_b32 s81, s77, 7
  s_add_u32 s78, s78, s81
  s_add_u32 s78, s78, 0x100000
  v_mul_u32_u24 v169, 4224, v161
  v_lshl_add_u32 v169, v160, 4, v169
  v_add_u32 v169, s78, v169
  s_mov_b32 s97, 33792
  s_lshr_b32 s78, s77, 3
  s_lshl_b32 s99, s74, 11
  s_lshl_b32 s81, s70, 9
  s_add_u32 s99, s99, s81
  s_mul_i32 s81, s78, 96
  s_add_u32 s99, s99, s81
  s_lshl_b32 s81, s77, 2
  s_add_u32 s99, s99, s81
  s_add_u32 s99, s99, 0x60000
  v_bfe_u32 v4, v1, 1, 3
  v_xor_b32 v4, v4, v29
  s_lshr_b32 s79, s70, 1
  s_lshl_b32 s79, s79, 13
  v_lshl_add_u32 v30, v4, 4, s79
  v_lshl_add_u32 v30, v28, 7, v30
  v_xor_b32 v31, 32, v30
  v_xor_b32 v32, 64, v30
  v_xor_b32 v33, 96, v30
  s_lshl_b32 s79, s6, 6
  v_xor_b32 v36, s79, v30
  v_xor_b32 v37, s79, v31
  v_bfe_u32 v4, v1, 1, 3
  v_xor_b32 v4, v4, v162
  s_lshr_b32 s79, s70, 1
  s_lshl_b32 s79, s79, 13
  v_lshl_add_u32 v34, v4, 4, s79
  v_lshl_add_u32 v34, v163, 7, v34
  v_xor_b32 v35, 64, v34
  v_and_b32 v4, 1, v1
  v_bfe_u32 v5, v1, 1, 1
  v_bfe_u32 v6, v1, 3, 1
  s_lshl_b32 s79, s6, 11
  s_add_u32 s79, s79, 0x4000
  v_mul_u32_u24 v30, 1056, v7
  v_lshl_add_u32 v30, v29, 12, v30
  v_lshl_add_u32 v30, v9, 7, v30
  v_lshl_add_u32 v30, v6, 6, v30
  v_lshl_add_u32 v30, v4, 4, v30
  v_lshl_add_u32 v30, v5, 3, v30
  v_add_u32 v30, s79, v30
  v_xor_b32 v31, 32, v30
  v_xor_b32 v32, 64, v30
  v_xor_b32 v33, 96, v30
  v_lshlrev_b32 v18, 4, v1
  v_mov_b32 v19, 1
  s_lshl_b32 s78, s70, 2
  s_add_u32 s78, s78, 0x27f00
  v_mov_b32 v15, s78
  v_lshlrev_b32 v16, 2, v8
  v_add_u32 v16, 0x27f00, v16
  v_and_b32 v4, 1, v1
  v_bfe_u32 v5, v1, 1, 1
  v_bfe_u32 v6, v1, 3, 1
  s_lshl_b32 s79, s6, 13
  v_lshl_add_u32 v25, v29, 9, s79
  v_lshl_add_u32 v25, v9, 7, v25
  v_lshl_add_u32 v25, v6, 6, v25
  v_lshl_add_u32 v25, v7, 5, v25
  v_lshl_add_u32 v25, v4, 4, v25
  v_lshl_add_u32 v25, v5, 3, v25
  s_lshl_b32 s79, s6, 6
  v_xor_b32 v25, s79, v25
  v_xor_b32 v24, 64, v25
  v_add_u32 v26, 0x10000, v24
  v_add_u32 v27, 0x10000, v25
  s_mul_i32 s90, s74, 114688
  s_lshr_b32 s78, s71, 1
  s_mul_i32 s78, s78, 3
  s_add_u32 s78, s78, 1
  s_lshr_b32 s78, s78, 1
  s_add_u32 s78, s78, s74
  s_mul_i32 s78, s78, 114688
  s_cmp_ge_u32 s78, 802816
  s_cselect_b32 s79, 802816, 0
  s_sub_u32 s78, s78, s79
  s_add_u32 s80, s90, 114688
  s_cmp_ge_u32 s80, 802816
  s_cselect_b32 s80, 0, s80
  s_add_u32 s91, s78, 114688
  s_cmp_ge_u32 s91, 802816
  s_cselect_b32 s91, 0, s91
  s_add_u32 s92, s91, 114688
  s_cmp_ge_u32 s92, 802816
  s_cselect_b32 s92, 0, s92
  s_cmp_eq_u32 s92, s90
  s_cselect_b32 s92, s80, s92
  s_add_u32 s93, s92, 114688
  s_cmp_ge_u32 s93, 802816
  s_cselect_b32 s93, 0, s93
  s_cmp_eq_u32 s93, s90
  s_cselect_b32 s93, s80, s93
  s_add_u32 s94, s93, 114688
  s_cmp_ge_u32 s94, 802816
  s_cselect_b32 s94, 0, s94
  s_cmp_eq_u32 s94, s90
  s_cselect_b32 s94, s80, s94
  s_add_u32 s95, s94, 114688
  s_cmp_ge_u32 s95, 802816
  s_cselect_b32 s95, 0, s95
  s_cmp_eq_u32 s95, s90
  s_cselect_b32 s95, s80, s95
  s_add_u32 s96, s95, 114688
  s_cmp_ge_u32 s96, 802816
  s_cselect_b32 s96, 0, s96
  s_cmp_eq_u32 s96, s90
  s_cselect_b32 s96, s80, s96
  s_mov_b32 s61, 0x10001
  s_mov_b32 s64, 0xbdd2d3e8
  s_mov_b32 s65, 0xbdd2d3e8
  v_mov_b32 v38, 0xc0135761
  v_mov_b32 v39, 0xc0135761
  s_mul_i32 s79, s75, 43
  s_lshr_b32 s79, s79, 7
  s_mul_i32 s80, s79, 1507328
  s_lshl_b32 s81, s75, 15
  s_add_u32 s80, s80, s81
  s_mul_i32 s81, s87, 802816
  s_add_u32 s80, s80, s81
  s_lshl_b32 s81, s70, 13
  s_add_u32 s80, s80, s81
  s_add_u32 s80, s80, 0x500000
  v_add_u32 v40, s80, v18
  v_lshl_add_u32 v11, v1, 7, s80
  v_add_u32 v41, 4096, v40
  s_lshr_b32 s79, s70, 1
  s_mul_i32 s78, s74, 270336
  s_mul_i32 s81, s6, 135168
  s_add_u32 s78, s78, s81
  s_lshl_b32 s81, s77, 7
  s_add_u32 s78, s78, s81
  s_lshl_b32 s81, s79, 6
  s_add_u32 s78, s78, s81
  s_add_u32 s78, s78, 0x300000
  v_lshrrev_b32 v4, 2, v1
  v_mul_u32_u24 v42, 4224, v4
  v_lshl_add_u32 v42, v8, 4, v42
  v_add_u32 v42, s78, v42
  s_lshl_b32 s78, s77, 9
  s_lshl_b32 s81, s79, 8
  s_add_u32 s78, s78, s81
  s_add_u32 s78, s78, 0x8000
  v_lshl_add_u32 v43, v28, 3, s78
  s_mul_i32 s78, s70, 11920
  s_add_u32 s78, s78, 0x1c000
  v_add_u32 v46, s78, v18
  v_lshl_add_u32 v45, v29, 9, s78
  v_lshl_add_u32 v45, v9, 6, v45
  v_lshl_add_u32 v45, v7, 5, v45
  v_lshl_add_u32 v45, v8, 3, v45
  v_lshl_add_u32 v47, v1, 2, s78
  s_lshl_b32 s62, s77, 10
  s_lshl_b32 s81, s70, 8
  s_add_u32 s62, s62, s81
  s_add_u32 s62, s62, 0x80000
  s_lshl_b32 s100, s74, 2
  s_add_u32 s100, s100, s62
  s_mov_b32 s56, 67584
  s_xor_b32 s78, s77, 1
  s_mul_i32 s57, s78, 114688
  s_lshl_b32 s81, s74, 14
  s_add_u32 s57, s57, s81
  s_lshl_b32 s81, s70, 12
  s_add_u32 s57, s57, s81
  s_add_u32 s57, s57, 0xe40000
  s_xor_b32 s60, s57, 4096
  s_mul_i32 s63, s77, 114688
  s_lshl_b32 s81, s74, 14
  s_add_u32 s63, s63, s81
  s_lshl_b32 s81, s70, 12
  s_add_u32 s63, s63, s81
  s_add_u32 s63, s63, 0xe40000
  s_xor_b32 s79, s70, 1
  s_mul_i32 s78, s79, 11920
  s_add_u32 s78, s78, 0x1c000
  v_add_u32 v44, s78, v18
  s_waitcnt lgkmcnt(0)
  s_add_u32 s82, s82, 0x9e3779b9
  s_mov_b32 s101, s83
  s_mov_b32 s83, s82
  v_mov_b32 v2, s82
  v_lshlrev_b32 v23, 3, v1
  v_bfe_u32 v23, v2, v23, 8
  v_lshl_or_b32 v23, v23, 15, v23
  v_and_b32 v20, s61, v23
  v_lshrrev_b32 v21, 2, v23
  v_and_b32 v21, s61, v21
  v_lshrrev_b32 v22, 4, v23
  v_and_b32 v22, s61, v22
  v_lshrrev_b32 v23, 6, v23
  v_and_b32 v23, s61, v23
  s_barrier
  ds_read_b64 v[164:165], v164
  ds_read_b64_tr_b16 v[170:171], v166 offset:0
  ds_read_b64_tr_b16 v[172:173], v166 offset:512
  ds_read_b64_tr_b16 v[174:175], v166 offset:1024
  ds_read_b64_tr_b16 v[176:177], v166 offset:1536
  ds_read_b64_tr_b16 v[178:179], v166 offset:2048
  ds_read_b64_tr_b16 v[180:181], v166 offset:8704
  ds_read_b64_tr_b16 v[182:183], v166 offset:9216
  ds_read_b64_tr_b16 v[184:185], v166 offset:9728
  ds_read_b64_tr_b16 v[186:187], v166 offset:10240
  s_waitcnt lgkmcnt(9)
  v_lshlrev_b32 v232, 16, v164
  v_and_b32 v233, 0xffff0000, v164
  v_lshlrev_b32 v234, 16, v165
  v_and_b32 v235, 0xffff0000, v165
  s_waitcnt lgkmcnt(4)
  v_lshlrev_b32 v189, 16, v171
  v_lshlrev_b32 v190, 16, v172
  v_lshlrev_b32 v191, 16, v173
  v_lshlrev_b32 v192, 16, v174
  v_lshlrev_b32 v193, 16, v175
  v_lshlrev_b32 v194, 16, v176
  v_lshlrev_b32 v195, 16, v177
  v_lshlrev_b32 v196, 16, v178
  v_lshlrev_b32 v197, 16, v179
  v_and_b32 v170, 0xffff0000, v170
  v_and_b32 v171, 0xffff0000, v171
  v_and_b32 v172, 0xffff0000, v172
  v_and_b32 v173, 0xffff0000, v173
  v_and_b32 v174, 0xffff0000, v174
  v_and_b32 v175, 0xffff0000, v175
  v_and_b32 v176, 0xffff0000, v176
  v_and_b32 v177, 0xffff0000, v177
  v_and_b32 v178, 0xffff0000, v178
  v_and_b32 v179, 0xffff0000, v179
  v_mul_f32 v200, v190, v232
  v_mul_f32 v201, v172, v232
  v_mul_f32 v202, v191, v232
  v_mul_f32 v203, v173, v232
  v_mul_f32 v204, v192, v232
  v_mul_f32 v205, v174, v232
  v_mul_f32 v206, v193, v232
  v_mul_f32 v207, v175, v232
  v_mul_f32 v208, v194, v232
  v_mul_f32 v209, v176, v232
  v_mul_f32 v210, v195, v232
  v_mul_f32 v211, v177, v232
  v_mul_f32 v212, v196, v232
  v_mul_f32 v213, v178, v232
  v_mul_f32 v214, v197, v232
  v_mul_f32 v215, v179, v232
  v_fmac_f32 v200, v171, v233
  v_fmac_f32 v201, v190, v233
  v_fmac_f32 v202, v172, v233
  v_fmac_f32 v203, v191, v233
  v_fmac_f32 v204, v173, v233
  v_fmac_f32 v205, v192, v233
  v_fmac_f32 v206, v174, v233
  v_fmac_f32 v207, v193, v233
  v_fmac_f32 v208, v175, v233
  v_fmac_f32 v209, v194, v233
  v_fmac_f32 v210, v176, v233
  v_fmac_f32 v211, v195, v233
  v_fmac_f32 v212, v177, v233
  v_fmac_f32 v213, v196, v233
  v_fmac_f32 v214, v178, v233
  v_fmac_f32 v215, v197, v233
  v_fmac_f32 v200, v189, v234
  v_fmac_f32 v201, v171, v234
  v_fmac_f32 v202, v190, v234
  v_fmac_f32 v203, v172, v234
  v_fmac_f32 v204, v191, v234
  v_fmac_f32 v205, v173, v234
  v_fmac_f32 v206, v192, v234
  v_fmac_f32 v207, v174, v234
  v_fmac_f32 v208, v193, v234
  v_fmac_f32 v209, v175, v234
  v_fmac_f32 v210, v194, v234
  v_fmac_f32 v211, v176, v234
  v_fmac_f32 v212, v195, v234
  v_fmac_f32 v213, v177, v234
  v_fmac_f32 v214, v196, v234
  v_fmac_f32 v215, v178, v234
  v_fmac_f32 v200, v170, v235
  v_fmac_f32 v201, v189, v235
  v_fmac_f32 v202, v171, v235
  v_fmac_f32 v203, v190, v235
  v_fmac_f32 v204, v172, v235
  v_fmac_f32 v205, v191, v235
  v_fmac_f32 v206, v173, v235
  v_fmac_f32 v207, v192, v235
  v_fmac_f32 v208, v174, v235
  v_fmac_f32 v209, v193, v235
  v_fmac_f32 v210, v175, v235
  v_fmac_f32 v211, v194, v235
  v_fmac_f32 v212, v176, v235
  v_fmac_f32 v213, v195, v235
  v_fmac_f32 v214, v177, v235
  v_fmac_f32 v215, v196, v235
  s_waitcnt lgkmcnt(0)
  v_lshlrev_b32 v216, 16, v180
  v_and_b32 v217, 0xffff0000, v180
  v_lshlrev_b32 v218, 16, v181
  v_and_b32 v219, 0xffff0000, v181
  v_lshlrev_b32 v220, 16, v182
  v_and_b32 v221, 0xffff0000, v182
  v_lshlrev_b32 v222, 16, v183
  v_and_b32 v223, 0xffff0000, v183
  v_lshlrev_b32 v224, 16, v184
  v_and_b32 v225, 0xffff0000, v184
  v_lshlrev_b32 v226, 16, v185
  v_and_b32 v227, 0xffff0000, v185
  v_lshlrev_b32 v228, 16, v186
  v_and_b32 v229, 0xffff0000, v186
  v_lshlrev_b32 v230, 16, v187
  v_and_b32 v231, 0xffff0000, v187
  v_mul_f32 v200, v200, v216
  v_mul_f32 v201, v201, v217
  v_mul_f32 v202, v202, v218
  v_mul_f32 v203, v203, v219
  v_mul_f32 v204, v204, v220
  v_mul_f32 v205, v205, v221
  v_mul_f32 v206, v206, v222
  v_mul_f32 v207, v207, v223
  v_mul_f32 v208, v208, v224
  v_mul_f32 v209, v209, v225
  v_mul_f32 v210, v210, v226
  v_mul_f32 v211, v211, v227
  v_mul_f32 v212, v212, v228
  v_mul_f32 v213, v213, v229
  v_mul_f32 v214, v214, v230
  v_mul_f32 v215, v215, v231
  v_cvt_pk_bf16_f32 v232, v200, v204
  v_cvt_pk_bf16_f32 v233, v208, v212
  v_cvt_pk_bf16_f32 v234, v202, v206
  v_cvt_pk_bf16_f32 v235, v210, v214
  v_cvt_pk_bf16_f32 v236, v201, v205
  v_cvt_pk_bf16_f32 v237, v209, v213
  v_cvt_pk_bf16_f32 v238, v203, v207
  v_cvt_pk_bf16_f32 v239, v211, v215
  ds_write_b128 v167, v[232:235]
  ds_write_b128 v167, v[236:239] offset:16
  ds_read_b128 v[200:203], v168
  ds_read_b128 v[204:207], v168 offset:1152
  s_waitcnt lgkmcnt(0)
  buffer_store_dwordx4 v[200:203], v169, s[36:39], 0 offen sc1
  buffer_store_dwordx4 v[204:207], v169, s[36:39], s97 offen sc1
  s_waitcnt vmcnt(2)
  v_lshlrev_b32 v240, 16, v64
  v_and_b32 v241, 0xffff0000, v64
  v_lshlrev_b32 v242, 16, v65
  v_and_b32 v243, 0xffff0000, v65
  v_lshlrev_b32 v244, 16, v66
  v_and_b32 v245, 0xffff0000, v66
  v_lshlrev_b32 v246, 16, v67
  v_and_b32 v247, 0xffff0000, v67
  v_lshlrev_b32 v248, 16, v68
  v_and_b32 v249, 0xffff0000, v68
  v_lshlrev_b32 v250, 16, v69
  v_and_b32 v251, 0xffff0000, v69
  v_lshlrev_b32 v252, 16, v70
  v_and_b32 v253, 0xffff0000, v70
  v_lshlrev_b32 v254, 16, v71
  v_and_b32 v255, 0xffff0000, v71
  s_setprio 2
  s_barrier
  ds_read_b64_tr_b16 v[144:145], v30 offset:0
  ds_read_b64_tr_b16 v[146:147], v30 offset:512
  ds_read_b128 v[128:131], v34 offset:0
  ds_read_b128 v[132:135], v34 offset:2048
  ds_read_b128 v[136:139], v34 offset:4096
  ds_read_b128 v[140:143], v34 offset:6144
  ds_read_b64_tr_b16 v[148:149], v31 offset:0
  ds_read_b64_tr_b16 v[150:151], v31 offset:512
  ds_read_b64_tr_b16 v[152:153], v32 offset:0
  ds_read_b64_tr_b16 v[154:155], v32 offset:512
  ds_read_b64_tr_b16 v[156:157], v33 offset:0
  ds_read_b64_tr_b16 v[158:159], v33 offset:512
  s_waitcnt lgkmcnt(9)
  v_mfma_f32_16x16x32_bf16 v[64:67], v[144:147], v[128:131], v[240:243]
  ds_read_b64_tr_b16 v[176:177], v30 offset:8192
  s_waitcnt lgkmcnt(9)
  v_mfma_f32_16x16x32_bf16 v[68:71], v[144:147], v[132:135], v[240:243]
  ds_read_b64_tr_b16 v[178:179], v30 offset:8704
  s_waitcnt lgkmcnt(9)
  v_mfma_f32_16x16x32_bf16 v[96:99], v[144:147], v[136:139], v[240:243]
  ds_read_b128 v[160:163], v35 offset:0
  s_waitcnt lgkmcnt(9)
  v_mfma_f32_16x16x32_bf16 v[100:103], v[144:147], v[140:143], v[240:243]
  ds_read_b128 v[164:167], v35 offset:2048
  s_waitcnt lgkmcnt(8)
  v_mfma_f32_16x16x32_bf16 v[72:75], v[148:151], v[128:131], v[244:247]
  ds_read_b128 v[168:171], v35 offset:4096
  v_mfma_f32_16x16x32_bf16 v[76:79], v[148:151], v[132:135], v[244:247]
  ds_read_b128 v[172:175], v35 offset:6144
  v_mfma_f32_16x16x32_bf16 v[104:107], v[148:151], v[136:139], v[244:247]
  ds_read_b64_tr_b16 v[180:181], v31 offset:8192
  ds_read_b64_tr_b16 v[182:183], v31 offset:8704
  v_mfma_f32_16x16x32_bf16 v[108:111], v[148:151], v[140:143], v[244:247]
  ds_read_b64_tr_b16 v[184:185], v32 offset:8192
  s_waitcnt lgkmcnt(11)
  v_mfma_f32_16x16x32_bf16 v[80:83], v[152:155], v[128:131], v[248:251]
  ds_read_b64_tr_b16 v[186:187], v32 offset:8704
  v_mfma_f32_16x16x32_bf16 v[84:87], v[152:155], v[132:135], v[248:251]
  ds_read_b64_tr_b16 v[188:189], v33 offset:8192
  v_mfma_f32_16x16x32_bf16 v[112:115], v[152:155], v[136:139], v[248:251]
  ds_read_b64_tr_b16 v[190:191], v33 offset:8704
  v_mfma_f32_16x16x32_bf16 v[116:119], v[152:155], v[140:143], v[248:251]
  s_waitcnt lgkmcnt(12)
  v_mfma_f32_16x16x32_bf16 v[88:91], v[156:159], v[128:131], v[252:255]
  v_mfma_f32_16x16x32_bf16 v[92:95], v[156:159], v[132:135], v[252:255]
  v_mfma_f32_16x16x32_bf16 v[120:123], v[156:159], v[136:139], v[252:255]
  v_mfma_f32_16x16x32_bf16 v[124:127], v[156:159], v[140:143], v[252:255]
  s_waitcnt lgkmcnt(0)
  s_barrier
  ds_read_b64_tr_b16 v[144:145], v30 offset:32768
  ds_read_b64_tr_b16 v[146:147], v30 offset:33280
  v_mfma_f32_16x16x32_bf16 v[64:67], v[176:179], v[160:163], v[64:67]
  ds_read_b128 v[128:131], v34 offset:32768
  v_mfma_f32_16x16x32_bf16 v[68:71], v[176:179], v[164:167], v[68:71]
  ds_read_b128 v[132:135], v34 offset:34816
  v_mfma_f32_16x16x32_bf16 v[96:99], v[176:179], v[168:171], v[96:99]
  ds_read_b128 v[136:139], v34 offset:36864
  v_mfma_f32_16x16x32_bf16 v[100:103], v[176:179], v[172:175], v[100:103]
  ds_read_b128 v[140:143], v34 offset:38912
  v_mfma_f32_16x16x32_bf16 v[72:75], v[180:183], v[160:163], v[72:75]
  v_mfma_f32_16x16x32_bf16 v[76:79], v[180:183], v[164:167], v[76:79]
  ds_read_b64_tr_b16 v[148:149], v31 offset:32768
  v_mfma_f32_16x16x32_bf16 v[104:107], v[180:183], v[168:171], v[104:107]
  ds_read_b64_tr_b16 v[150:151], v31 offset:33280
  v_mfma_f32_16x16x32_bf16 v[108:111], v[180:183], v[172:175], v[108:111]
  ds_read_b64_tr_b16 v[152:153], v32 offset:32768
  v_mfma_f32_16x16x32_bf16 v[80:83], v[184:187], v[160:163], v[80:83]
  ds_read_b64_tr_b16 v[154:155], v32 offset:33280
  v_mfma_f32_16x16x32_bf16 v[84:87], v[184:187], v[164:167], v[84:87]
  ds_read_b64_tr_b16 v[156:157], v33 offset:32768
  v_mfma_f32_16x16x32_bf16 v[112:115], v[184:187], v[168:171], v[112:115]
  ds_read_b64_tr_b16 v[158:159], v33 offset:33280
  v_mfma_f32_16x16x32_bf16 v[116:119], v[184:187], v[172:175], v[116:119]
  v_mfma_f32_16x16x32_bf16 v[88:91], v[188:191], v[160:163], v[88:91]
  v_mfma_f32_16x16x32_bf16 v[92:95], v[188:191], v[164:167], v[92:95]
  v_mfma_f32_16x16x32_bf16 v[120:123], v[188:191], v[168:171], v[120:123]
  v_mfma_f32_16x16x32_bf16 v[124:127], v[188:191], v[172:175], v[124:127]
  s_waitcnt vmcnt(0)
  s_mov_b64 exec, 1
  buffer_store_dword v2, off, s[36:39], s99 sc1
  s_mov_b64 exec, -1
  s_waitcnt lgkmcnt(6)
  v_mfma_f32_16x16x32_bf16 v[64:67], v[144:147], v[128:131], v[64:67]
  ds_read_b64_tr_b16 v[176:177], v30 offset:40960
  v_mfma_f32_16x16x32_bf16 v[68:71], v[144:147], v[132:135], v[68:71]
  ds_read_b64_tr_b16 v[178:179], v30 offset:41472
  v_mfma_f32_16x16x32_bf16 v[96:99], v[144:147], v[136:139], v[96:99]
  ds_read_b128 v[160:163], v35 offset:32768
  v_mfma_f32_16x16x32_bf16 v[100:103], v[144:147], v[140:143], v[100:103]
  ds_read_b128 v[164:167], v35 offset:34816
  ds_read_b128 v[168:171], v35 offset:36864
  s_waitcnt lgkmcnt(9)
  v_mfma_f32_16x16x32_bf16 v[72:75], v[148:151], v[128:131], v[72:75]
  ds_read_b128 v[172:175], v35 offset:38912
  v_mfma_f32_16x16x32_bf16 v[76:79], v[148:151], v[132:135], v[76:79]
  ds_read_b64_tr_b16 v[180:181], v31 offset:40960
  v_mfma_f32_16x16x32_bf16 v[104:107], v[148:151], v[136:139], v[104:107]
  ds_read_b64_tr_b16 v[182:183], v31 offset:41472
  v_mfma_f32_16x16x32_bf16 v[108:111], v[148:151], v[140:143], v[108:111]
  ds_read_b64_tr_b16 v[184:185], v32 offset:40960
  s_waitcnt lgkmcnt(11)
  v_mfma_f32_16x16x32_bf16 v[80:83], v[152:155], v[128:131], v[80:83]
  ds_read_b64_tr_b16 v[186:187], v32 offset:41472
  v_mfma_f32_16x16x32_bf16 v[84:87], v[152:155], v[132:135], v[84:87]
  ds_read_b64_tr_b16 v[188:189], v33 offset:40960
  v_mfma_f32_16x16x32_bf16 v[112:115], v[152:155], v[136:139], v[112:115]
  ds_read_b64_tr_b16 v[190:191], v33 offset:41472
  v_mfma_f32_16x16x32_bf16 v[116:119], v[152:155], v[140:143], v[116:119]
  v_add_u32 v34, 0x10000, v34
  v_add_u32 v35, 0x10000, v35
  s_waitcnt lgkmcnt(12)
  v_mfma_f32_16x16x32_bf16 v[88:91], v[156:159], v[128:131], v[88:91]
  v_add_u32 v30, 0x10000, v30
  v_mfma_f32_16x16x32_bf16 v[92:95], v[156:159], v[132:135], v[92:95]
  v_add_u32 v31, 0x10000, v31
  v_mfma_f32_16x16x32_bf16 v[120:123], v[156:159], v[136:139], v[120:123]
  v_add_u32 v32, 0x10000, v32
  v_mfma_f32_16x16x32_bf16 v[124:127], v[156:159], v[140:143], v[124:127]
  v_add_u32 v33, 0x10000, v33
  s_waitcnt lgkmcnt(0)
  s_barrier
  ds_read_b64_tr_b16 v[144:145], v30 offset:0
  ds_read_b64_tr_b16 v[146:147], v30 offset:512
  v_mfma_f32_16x16x32_bf16 v[64:67], v[176:179], v[160:163], v[64:67]
  ds_read_b128 v[128:131], v34 offset:0
  v_mfma_f32_16x16x32_bf16 v[68:71], v[176:179], v[164:167], v[68:71]
  ds_read_b128 v[132:135], v34 offset:2048
  v_mfma_f32_16x16x32_bf16 v[96:99], v[176:179], v[168:171], v[96:99]
  ds_read_b128 v[136:139], v34 offset:4096
  v_mfma_f32_16x16x32_bf16 v[100:103], v[176:179], v[172:175], v[100:103]
  ds_read_b128 v[140:143], v34 offset:6144
  v_mfma_f32_16x16x32_bf16 v[72:75], v[180:183], v[160:163], v[72:75]
  v_mfma_f32_16x16x32_bf16 v[76:79], v[180:183], v[164:167], v[76:79]
  ds_read_b64_tr_b16 v[148:149], v31 offset:0
  v_mfma_f32_16x16x32_bf16 v[104:107], v[180:183], v[168:171], v[104:107]
  ds_read_b64_tr_b16 v[150:151], v31 offset:512
  v_mfma_f32_16x16x32_bf16 v[108:111], v[180:183], v[172:175], v[108:111]
  ds_read_b64_tr_b16 v[152:153], v32 offset:0
  v_mfma_f32_16x16x32_bf16 v[80:83], v[184:187], v[160:163], v[80:83]
  ds_read_b64_tr_b16 v[154:155], v32 offset:512
  v_mfma_f32_16x16x32_bf16 v[84:87], v[184:187], v[164:167], v[84:87]
  ds_read_b64_tr_b16 v[156:157], v33 offset:0
  v_mfma_f32_16x16x32_bf16 v[112:115], v[184:187], v[168:171], v[112:115]
  ds_read_b64_tr_b16 v[158:159], v33 offset:512
  v_mfma_f32_16x16x32_bf16 v[116:119], v[184:187], v[172:175], v[116:119]
  v_mfma_f32_16x16x32_bf16 v[88:91], v[188:191], v[160:163], v[88:91]
  v_mfma_f32_16x16x32_bf16 v[92:95], v[188:191], v[164:167], v[92:95]
  v_mfma_f32_16x16x32_bf16 v[120:123], v[188:191], v[168:171], v[120:123]
  v_mfma_f32_16x16x32_bf16 v[124:127], v[188:191], v[172:175], v[124:127]
  s_waitcnt lgkmcnt(6)
  v_mfma_f32_16x16x32_bf16 v[64:67], v[144:147], v[128:131], v[64:67]
  ds_read_b64_tr_b16 v[176:177], v30 offset:8192
  v_mfma_f32_16x16x32_bf16 v[68:71], v[144:147], v[132:135], v[68:71]
  ds_read_b64_tr_b16 v[178:179], v30 offset:8704
  v_mfma_f32_16x16x32_bf16 v[96:99], v[144:147], v[136:139], v[96:99]
  ds_read_b128 v[160:163], v35 offset:0
  v_mfma_f32_16x16x32_bf16 v[100:103], v[144:147], v[140:143], v[100:103]
  ds_read_b128 v[164:167], v35 offset:2048
  s_waitcnt lgkmcnt(8)
  v_mfma_f32_16x16x32_bf16 v[72:75], v[148:151], v[128:131], v[72:75]
  ds_read_b128 v[168:171], v35 offset:4096
  v_mfma_f32_16x16x32_bf16 v[76:79], v[148:151], v[132:135], v[76:79]
  ds_read_b128 v[172:175], v35 offset:6144
  v_mfma_f32_16x16x32_bf16 v[104:107], v[148:151], v[136:139], v[104:107]
  ds_read_b64_tr_b16 v[180:181], v31 offset:8192
  ds_read_b64_tr_b16 v[182:183], v31 offset:8704
  v_mfma_f32_16x16x32_bf16 v[108:111], v[148:151], v[140:143], v[108:111]
  ds_read_b64_tr_b16 v[184:185], v32 offset:8192
  s_waitcnt lgkmcnt(11)
  v_mfma_f32_16x16x32_bf16 v[80:83], v[152:155], v[128:131], v[80:83]
  ds_read_b64_tr_b16 v[186:187], v32 offset:8704
L_stub2:
  s_cbranch_execz L_stub3
  v_mfma_f32_16x16x32_bf16 v[84:87], v[152:155], v[132:135], v[84:87]
  ds_read_b64_tr_b16 v[188:189], v33 offset:8192
  v_mfma_f32_16x16x32_bf16 v[112:115], v[152:155], v[136:139], v[112:115]
  ds_read_b64_tr_b16 v[190:191], v33 offset:8704
  v_mfma_f32_16x16x32_bf16 v[116:119], v[152:155], v[140:143], v[116:119]
  s_waitcnt lgkmcnt(12)
  v_mfma_f32_16x16x32_bf16 v[88:91], v[156:159], v[128:131], v[88:91]
  v_mfma_f32_16x16x32_bf16 v[92:95], v[156:159], v[132:135], v[92:95]
  v_mfma_f32_16x16x32_bf16 v[120:123], v[156:159], v[136:139], v[120:123]
  v_mfma_f32_16x16x32_bf16 v[124:127], v[156:159], v[140:143], v[124:127]
  s_waitcnt lgkmcnt(0)
  s_barrier
  ds_read_b64_tr_b16 v[144:145], v30 offset:32768
  ds_read_b64_tr_b16 v[146:147], v30 offset:33280
  v_mfma_f32_16x16x32_bf16 v[64:67], v[176:179], v[160:163], v[64:67]
  ds_read_b128 v[128:131], v34 offset:32768
  v_mfma_f32_16x16x32_bf16 v[68:71], v[176:179], v[164:167], v[68:71]
  ds_read_b128 v[132:135], v34 offset:34816
  v_mfma_f32_16x16x32_bf16 v[96:99], v[176:179], v[168:171], v[96:99]
  ds_read_b128 v[136:139], v34 offset:36864
  v_mfma_f32_16x16x32_bf16 v[100:103], v[176:179], v[172:175], v[100:103]
  ds_read_b128 v[140:143], v34 offset:38912
  v_mfma_f32_16x16x32_bf16 v[72:75], v[180:183], v[160:163], v[72:75]
  v_mfma_f32_16x16x32_bf16 v[76:79], v[180:183], v[164:167], v[76:79]
  ds_read_b64_tr_b16 v[148:149], v31 offset:32768
  v_mfma_f32_16x16x32_bf16 v[104:107], v[180:183], v[168:171], v[104:107]
  ds_read_b64_tr_b16 v[150:151], v31 offset:33280
  v_mfma_f32_16x16x32_bf16 v[108:111], v[180:183], v[172:175], v[108:111]
  ds_read_b64_tr_b16 v[152:153], v32 offset:32768
  v_mfma_f32_16x16x32_bf16 v[80:83], v[184:187], v[160:163], v[80:83]
  ds_read_b64_tr_b16 v[154:155], v32 offset:33280
  v_mfma_f32_16x16x32_bf16 v[84:87], v[184:187], v[164:167], v[84:87]
  ds_read_b64_tr_b16 v[156:157], v33 offset:32768
  v_mfma_f32_16x16x32_bf16 v[112:115], v[184:187], v[168:171], v[112:115]
  ds_read_b64_tr_b16 v[158:159], v33 offset:33280
  v_mfma_f32_16x16x32_bf16 v[116:119], v[184:187], v[172:175], v[116:119]
  v_mfma_f32_16x16x32_bf16 v[88:91], v[188:191], v[160:163], v[88:91]
  v_mfma_f32_16x16x32_bf16 v[92:95], v[188:191], v[164:167], v[92:95]
  v_mfma_f32_16x16x32_bf16 v[120:123], v[188:191], v[168:171], v[120:123]
  v_mfma_f32_16x16x32_bf16 v[124:127], v[188:191], v[172:175], v[124:127]
  s_waitcnt lgkmcnt(6)
  v_mfma_f32_16x16x32_bf16 v[64:67], v[144:147], v[128:131], v[64:67]
  ds_read_b64_tr_b16 v[176:177], v30 offset:40960
  v_mfma_f32_16x16x32_bf16 v[68:71], v[144:147], v[132:135], v[68:71]
  ds_read_b64_tr_b16 v[178:179], v30 offset:41472
  v_mfma_f32_16x16x32_bf16 v[96:99], v[144:147], v[136:139], v[96:99]
  ds_read_b128 v[160:163], v35 offset:32768
  v_mfma_f32_16x16x32_bf16 v[100:103], v[144:147], v[140:143], v[100:103]
  ds_read_b128 v[164:167], v35 offset:34816
  ds_read_b128 v[168:171], v35 offset:36864
  s_waitcnt lgkmcnt(9)
  v_mfma_f32_16x16x32_bf16 v[72:75], v[148:151], v[128:131], v[72:75]
  ds_read_b128 v[172:175], v35 offset:38912
  v_mfma_f32_16x16x32_bf16 v[76:79], v[148:151], v[132:135], v[76:79]
  ds_read_b64_tr_b16 v[180:181], v31 offset:40960
  v_mfma_f32_16x16x32_bf16 v[104:107], v[148:151], v[136:139], v[104:107]
  ds_read_b64_tr_b16 v[182:183], v31 offset:41472
  v_mfma_f32_16x16x32_bf16 v[108:111], v[148:151], v[140:143], v[108:111]
  ds_read_b64_tr_b16 v[184:185], v32 offset:40960
  s_waitcnt lgkmcnt(11)
  v_mfma_f32_16x16x32_bf16 v[80:83], v[152:155], v[128:131], v[80:83]
  ds_read_b64_tr_b16 v[186:187], v32 offset:41472
  v_mfma_f32_16x16x32_bf16 v[84:87], v[152:155], v[132:135], v[84:87]
  ds_read_b64_tr_b16 v[188:189], v33 offset:40960
  v_mfma_f32_16x16x32_bf16 v[112:115], v[152:155], v[136:139], v[112:115]
  ds_read_b64_tr_b16 v[190:191], v33 offset:41472
  v_mfma_f32_16x16x32_bf16 v[116:119], v[152:155], v[140:143], v[116:119]
  v_add_u32 v34, 0xffff0000, v34
  v_add_u32 v35, 0xffff0000, v35
  s_waitcnt lgkmcnt(12)
  v_mfma_f32_16x16x32_bf16 v[88:91], v[156:159], v[128:131], v[88:91]
  v_add_u32 v30, 0xffff0000, v30
  v_mfma_f32_16x16x32_bf16 v[92:95], v[156:159], v[132:135], v[92:95]
  v_add_u32 v31, 0xffff0000, v31
  v_mfma_f32_16x16x32_bf16 v[120:123], v[156:159], v[136:139], v[120:123]
  v_add_u32 v32, 0xffff0000, v32
  v_mfma_f32_16x16x32_bf16 v[124:127], v[156:159], v[140:143], v[124:127]
  v_add_u32 v33, 0xffff0000, v33
  s_waitcnt lgkmcnt(0)
  s_barrier
  ds_read_b64_tr_b16 v[144:145], v30 offset:0
  ds_read_b64_tr_b16 v[146:147], v30 offset:512
  v_mfma_f32_16x16x32_bf16 v[64:67], v[176:179], v[160:163], v[64:67]
  ds_read_b128 v[128:131], v34 offset:0
  v_mfma_f32_16x16x32_bf16 v[68:71], v[176:179], v[164:167], v[68:71]
  ds_read_b128 v[132:135], v34 offset:2048
  v_mfma_f32_16x16x32_bf16 v[96:99], v[176:179], v[168:171], v[96:99]
  ds_read_b128 v[136:139], v34 offset:4096
  v_mfma_f32_16x16x32_bf16 v[100:103], v[176:179], v[172:175], v[100:103]
  ds_read_b128 v[140:143], v34 offset:6144
  v_mfma_f32_16x16x32_bf16 v[72:75], v[180:183], v[160:163], v[72:75]
  v_mfma_f32_16x16x32_bf16 v[76:79], v[180:183], v[164:167], v[76:79]
  ds_read_b64_tr_b16 v[148:149], v31 offset:0
  v_mfma_f32_16x16x32_bf16 v[104:107], v[180:183], v[168:171], v[104:107]
  ds_read_b64_tr_b16 v[150:151], v31 offset:512
  v_mfma_f32_16x16x32_bf16 v[108:111], v[180:183], v[172:175], v[108:111]
  ds_read_b64_tr_b16 v[152:153], v32 offset:0
  v_mfma_f32_16x16x32_bf16 v[80:83], v[184:187], v[160:163], v[80:83]
  ds_read_b64_tr_b16 v[154:155], v32 offset:512
  v_mfma_f32_16x16x32_bf16 v[84:87], v[184:187], v[164:167], v[84:87]
  ds_read_b64_tr_b16 v[156:157], v33 offset:0
  v_mfma_f32_16x16x32_bf16 v[112:115], v[184:187], v[168:171], v[112:115]
  ds_read_b64_tr_b16 v[158:159], v33 offset:512
  v_mfma_f32_16x16x32_bf16 v[116:119], v[184:187], v[172:175], v[116:119]
  v_mfma_f32_16x16x32_bf16 v[88:91], v[188:191], v[160:163], v[88:91]
  v_mfma_f32_16x16x32_bf16 v[92:95], v[188:191], v[164:167], v[92:95]
  v_mfma_f32_16x16x32_bf16 v[120:123], v[188:191], v[168:171], v[120:123]
  v_mfma_f32_16x16x32_bf16 v[124:127], v[188:191], v[172:175], v[124:127]
  s_waitcnt lgkmcnt(6)
  v_mfma_f32_16x16x32_bf16 v[64:67], v[144:147], v[128:131], v[64:67]
  ds_read_b128 v[56:59], v36 offset:4096
  v_mfma_f32_16x16x32_bf16 v[68:71], v[144:147], v[132:135], v[68:71]
  ds_read_b128 v[60:63], v37 offset:4096
  ds_read_b64_tr_b16 v[176:177], v30 offset:8192
  v_mfma_f32_16x16x32_bf16 v[96:99], v[144:147], v[136:139], v[96:99]
  ds_read_b64_tr_b16 v[178:179], v30 offset:8704
  v_mfma_f32_16x16x32_bf16 v[100:103], v[144:147], v[140:143], v[100:103]
  ds_read_b128 v[160:163], v35 offset:0
  s_waitcnt lgkmcnt(9)
  v_mfma_f32_16x16x32_bf16 v[72:75], v[148:151], v[128:131], v[72:75]
  ds_read_b128 v[164:167], v35 offset:2048
  v_mfma_f32_16x16x32_bf16 v[76:79], v[148:151], v[132:135], v[76:79]
  ds_read_b128 v[168:171], v35 offset:4096
  ds_read_b128 v[172:175], v35 offset:6144
  v_mfma_f32_16x16x32_bf16 v[104:107], v[148:151], v[136:139], v[104:107]
  ds_read_b64_tr_b16 v[180:181], v31 offset:8192
  v_mfma_f32_16x16x32_bf16 v[108:111], v[148:151], v[140:143], v[108:111]
  ds_read_b64_tr_b16 v[182:183], v31 offset:8704
  s_waitcnt lgkmcnt(12)
  v_mfma_f32_16x16x32_bf16 v[80:83], v[152:155], v[128:131], v[80:83]
  ds_read_b64_tr_b16 v[184:185], v32 offset:8192
  v_mfma_f32_16x16x32_bf16 v[84:87], v[152:155], v[132:135], v[84:87]
  ds_read_b64_tr_b16 v[186:187], v32 offset:8704
  ds_read_b64_tr_b16 v[188:189], v33 offset:8192
  v_mfma_f32_16x16x32_bf16 v[112:115], v[152:155], v[136:139], v[112:115]
  ds_read_b64_tr_b16 v[190:191], v33 offset:8704
  v_mfma_f32_16x16x32_bf16 v[116:119], v[152:155], v[140:143], v[116:119]
  s_waitcnt lgkmcnt(14)
  v_mfma_f32_16x16x32_bf16 v[88:91], v[156:159], v[128:131], v[88:91]
  v_mfma_f32_16x16x32_bf16 v[92:95], v[156:159], v[132:135], v[92:95]
  v_mfma_f32_16x16x32_bf16 v[120:123], v[156:159], v[136:139], v[120:123]
  v_mfma_f32_16x16x32_bf16 v[124:127], v[156:159], v[140:143], v[124:127]
  s_waitcnt lgkmcnt(0)
  s_barrier
  ds_read_b64_tr_b16 v[144:145], v30 offset:32768
  ds_read_b64_tr_b16 v[146:147], v30 offset:33280
  v_mfma_f32_16x16x32_bf16 v[64:67], v[176:179], v[160:163], v[64:67]
  ds_read_b128 v[128:131], v34 offset:32768
  v_mfma_f32_16x16x32_bf16 v[68:71], v[176:179], v[164:167], v[68:71]
  ds_read_b128 v[132:135], v34 offset:34816
  v_mfma_f32_16x16x32_bf16 v[96:99], v[176:179], v[168:171], v[96:99]
  ds_read_b128 v[136:139], v34 offset:36864
  v_mfma_f32_16x16x32_bf16 v[100:103], v[176:179], v[172:175], v[100:103]
  ds_read_b128 v[140:143], v34 offset:38912
  v_mfma_f32_16x16x32_bf16 v[72:75], v[180:183], v[160:163], v[72:75]
  v_mfma_f32_16x16x32_bf16 v[76:79], v[180:183], v[164:167], v[76:79]
  ds_read_b64_tr_b16 v[148:149], v31 offset:32768
  v_mfma_f32_16x16x32_bf16 v[104:107], v[180:183], v[168:171], v[104:107]
  ds_read_b64_tr_b16 v[150:151], v31 offset:33280
  v_mfma_f32_16x16x32_bf16 v[108:111], v[180:183], v[172:175], v[108:111]
  ds_read_b64_tr_b16 v[152:153], v32 offset:32768
  v_mfma_f32_16x16x32_bf16 v[80:83], v[184:187], v[160:163], v[80:83]
  ds_read_b64_tr_b16 v[154:155], v32 offset:33280
  v_mfma_f32_16x16x32_bf16 v[84:87], v[184:187], v[164:167], v[84:87]
  ds_read_b64_tr_b16 v[156:157], v33 offset:32768
  v_mfma_f32_16x16x32_bf16 v[112:115], v[184:187], v[168:171], v[112:115]
  ds_read_b64_tr_b16 v[158:159], v33 offset:33280
  v_mfma_f32_16x16x32_bf16 v[116:119], v[184:187], v[172:175], v[116:119]
  v_mfma_f32_16x16x32_bf16 v[88:91], v[188:191], v[160:163], v[88:91]
  v_mfma_f32_16x16x32_bf16 v[92:95], v[188:191], v[164:167], v[92:95]
  v_mfma_f32_16x16x32_bf16 v[120:123], v[188:191], v[168:171], v[120:123]
  v_mfma_f32_16x16x32_bf16 v[124:127], v[188:191], v[172:175], v[124:127]
  s_waitcnt lgkmcnt(6)
  v_mfma_f32_16x16x32_bf16 v[64:67], v[144:147], v[128:131], v[64:67]
  ds_read_b64_tr_b16 v[176:177], v30 offset:40960
  v_mfma_f32_16x16x32_bf16 v[68:71], v[144:147], v[132:135], v[68:71]
  ds_read_b64_tr_b16 v[178:179], v30 offset:41472
  v_mfma_f32_16x16x32_bf16 v[96:99], v[144:147], v[136:139], v[96:99]
  ds_read_b128 v[160:163], v35 offset:32768
  v_mfma_f32_16x16x32_bf16 v[100:103], v[144:147], v[140:143], v[100:103]
  ds_read_b128 v[164:167], v35 offset:34816
  ds_read_b128 v[168:171], v35 offset:36864
  s_waitcnt lgkmcnt(9)
  v_mfma_f32_16x16x32_bf16 v[72:75], v[148:151], v[128:131], v[72:75]
  ds_read_b128 v[172:175], v35 offset:38912
  v_mfma_f32_16x16x32_bf16 v[76:79], v[148:151], v[132:135], v[76:79]
  ds_read_b64_tr_b16 v[180:181], v31 offset:40960
  v_mfma_f32_16x16x32_bf16 v[104:107], v[148:151], v[136:139], v[104:107]
  ds_read_b64_tr_b16 v[182:183], v31 offset:41472
  v_mfma_f32_16x16x32_bf16 v[108:111], v[148:151], v[140:143], v[108:111]
  ds_read_b64_tr_b16 v[184:185], v32 offset:40960
  s_waitcnt lgkmcnt(11)
  v_mfma_f32_16x16x32_bf16 v[80:83], v[152:155], v[128:131], v[80:83]
  ds_read_b64_tr_b16 v[186:187], v32 offset:41472
  v_mfma_f32_16x16x32_bf16 v[84:87], v[152:155], v[132:135], v[84:87]
  ds_read_b64_tr_b16 v[188:189], v33 offset:40960
  v_mfma_f32_16x16x32_bf16 v[112:115], v[152:155], v[136:139], v[112:115]
  ds_read_b64_tr_b16 v[190:191], v33 offset:41472
  v_mfma_f32_16x16x32_bf16 v[116:119], v[152:155], v[140:143], v[116:119]
  v_add_u32 v34, 0x10000, v34
  v_add_u32 v35, 0x10000, v35
  s_waitcnt lgkmcnt(12)
  v_mfma_f32_16x16x32_bf16 v[88:91], v[156:159], v[128:131], v[88:91]
  v_add_u32 v30, 0x10000, v30
  v_mfma_f32_16x16x32_bf16 v[92:95], v[156:159], v[132:135], v[92:95]
  v_add_u32 v31, 0x10000, v31
  v_mfma_f32_16x16x32_bf16 v[120:123], v[156:159], v[136:139], v[120:123]
  v_add_u32 v32, 0x10000, v32
  v_mfma_f32_16x16x32_bf16 v[124:127], v[156:159], v[140:143], v[124:127]
  v_add_u32 v33, 0x10000, v33
  s_waitcnt lgkmcnt(0)
  s_barrier
  ds_read_b64_tr_b16 v[144:145], v30 offset:0
  ds_read_b64_tr_b16 v[146:147], v30 offset:512
  v_mfma_f32_16x16x32_bf16 v[64:67], v[176:179], v[160:163], v[64:67]
  ds_read_b128 v[128:131], v34 offset:0
  v_mfma_f32_16x16x32_bf16 v[68:71], v[176:179], v[164:167], v[68:71]
  ds_read_b128 v[132:135], v34 offset:2048
  v_mfma_f32_16x16x32_bf16 v[96:99], v[176:179], v[168:171], v[96:99]
  ds_read_b128 v[136:139], v34 offset:4096
  v_mfma_f32_16x16x32_bf16 v[100:103], v[176:179], v[172:175], v[100:103]
  ds_read_b128 v[140:143], v34 offset:6144
  v_mfma_f32_16x16x32_bf16 v[72:75], v[180:183], v[160:163], v[72:75]
  v_mfma_f32_16x16x32_bf16 v[76:79], v[180:183], v[164:167], v[76:79]
  ds_read_b64_tr_b16 v[148:149], v31 offset:0
  v_mfma_f32_16x16x32_bf16 v[104:107], v[180:183], v[168:171], v[104:107]
  ds_read_b64_tr_b16 v[150:151], v31 offset:512
  v_mfma_f32_16x16x32_bf16 v[108:111], v[180:183], v[172:175], v[108:111]
  ds_read_b64_tr_b16 v[152:153], v32 offset:0
  v_mfma_f32_16x16x32_bf16 v[80:83], v[184:187], v[160:163], v[80:83]
  ds_read_b64_tr_b16 v[154:155], v32 offset:512
  v_mfma_f32_16x16x32_bf16 v[84:87], v[184:187], v[164:167], v[84:87]
  ds_read_b64_tr_b16 v[156:157], v33 offset:0
  v_mfma_f32_16x16x32_bf16 v[112:115], v[184:187], v[168:171], v[112:115]
  ds_read_b64_tr_b16 v[158:159], v33 offset:512
  v_mfma_f32_16x16x32_bf16 v[116:119], v[184:187], v[172:175], v[116:119]
  v_mfma_f32_16x16x32_bf16 v[88:91], v[188:191], v[160:163], v[88:91]
  v_mfma_f32_16x16x32_bf16 v[92:95], v[188:191], v[164:167], v[92:95]
  v_mfma_f32_16x16x32_bf16 v[120:123], v[188:191], v[168:171], v[120:123]
  v_mfma_f32_16x16x32_bf16 v[124:127], v[188:191], v[172:175], v[124:127]
  s_waitcnt lgkmcnt(6)
  v_mfma_f32_16x16x32_bf16 v[64:67], v[144:147], v[128:131], v[64:67]
  ds_read_b64_tr_b16 v[176:177], v30 offset:8192
  v_mfma_f32_16x16x32_bf16 v[68:71], v[144:147], v[132:135], v[68:71]
  ds_read_b64_tr_b16 v[178:179], v30 offset:8704
  v_mfma_f32_16x16x32_bf16 v[96:99], v[144:147], v[136:139], v[96:99]
  ds_read_b128 v[160:163], v35 offset:0
  v_mfma_f32_16x16x32_bf16 v[100:103], v[144:147], v[140:143], v[100:103]
  ds_read_b128 v[164:167], v35 offset:2048
  s_waitcnt lgkmcnt(8)
  v_mfma_f32_16x16x32_bf16 v[72:75], v[148:151], v[128:131], v[72:75]
  ds_read_b128 v[168:171], v35 offset:4096
  v_mfma_f32_16x16x32_bf16 v[76:79], v[148:151], v[132:135], v[76:79]
  ds_read_b128 v[172:175], v35 offset:6144
  v_mfma_f32_16x16x32_bf16 v[104:107], v[148:151], v[136:139], v[104:107]
  ds_read_b64_tr_b16 v[180:181], v31 offset:8192
  ds_read_b64_tr_b16 v[182:183], v31 offset:8704
  v_mfma_f32_16x16x32_bf16 v[108:111], v[148:151], v[140:143], v[108:111]
  ds_read_b64_tr_b16 v[184:185], v32 offset:8192
  s_waitcnt lgkmcnt(11)
  v_mfma_f32_16x16x32_bf16 v[80:83], v[152:155], v[128:131], v[80:83]
  ds_read_b64_tr_b16 v[186:187], v32 offset:8704
  v_mfma_f32_16x16x32_bf16 v[84:87], v[152:155], v[132:135], v[84:87]
  ds_read_b64_tr_b16 v[188:189], v33 offset:8192
  v_mfma_f32_16x16x32_bf16 v[112:115], v[152:155], v[136:139], v[112:115]
  ds_read_b64_tr_b16 v[190:191], v33 offset:8704
  v_mfma_f32_16x16x32_bf16 v[116:119], v[152:155], v[140:143], v[116:119]
  s_waitcnt lgkmcnt(12)
  v_mfma_f32_16x16x32_bf16 v[88:91], v[156:159], v[128:131], v[88:91]
  v_mfma_f32_16x16x32_bf16 v[92:95], v[156:159], v[132:135], v[92:95]
  v_mfma_f32_16x16x32_bf16 v[120:123], v[156:159], v[136:139], v[120:123]
  v_mfma_f32_16x16x32_bf16 v[124:127], v[156:159], v[140:143], v[124:127]
  s_waitcnt lgkmcnt(6)
  v_mfma_f32_16x16x32_bf16 v[64:67], v[176:179], v[160:163], v[64:67]
  v_mfma_f32_16x16x32_bf16 v[68:71], v[176:179], v[164:167], v[68:71]
  s_waitcnt lgkmcnt(4)
  v_mfma_f32_16x16x32_bf16 v[72:75], v[180:183], v[160:163], v[72:75]
  v_mfma_f32_16x16x32_bf16 v[76:79], v[180:183], v[164:167], v[76:79]
  s_waitcnt lgkmcnt(2)
  v_mfma_f32_16x16x32_bf16 v[80:83], v[184:187], v[160:163], v[80:83]
  v_mfma_f32_16x16x32_bf16 v[84:87], v[184:187], v[164:167], v[84:87]
  s_waitcnt lgkmcnt(0)
  v_mfma_f32_16x16x32_bf16 v[88:91], v[188:191], v[160:163], v[88:91]
  v_mfma_f32_16x16x32_bf16 v[92:95], v[188:191], v[164:167], v[92:95]
  v_mfma_f32_16x16x32_bf16 v[96:99], v[176:179], v[168:171], v[96:99]
  v_mul_f32 v128, v64, v64
  v_mul_f32 v129, v65, v65
  v_mfma_f32_16x16x32_bf16 v[100:103], v[176:179], v[172:175], v[100:103]
  v_mul_f32 v130, v66, v66
  v_mul_f32 v131, v67, v67
  v_mfma_f32_16x16x32_bf16 v[104:107], v[180:183], v[168:171], v[104:107]
  v_mul_f32 v132, v68, v68
  v_mul_f32 v133, v69, v69
  v_mfma_f32_16x16x32_bf16 v[108:111], v[180:183], v[172:175], v[108:111]
  v_mul_f32 v134, v70, v70
  v_mul_f32 v135, v71, v71
  v_mfma_f32_16x16x32_bf16 v[112:115], v[184:187], v[168:171], v[112:115]
  v_fma_f32 v128, v128, s64, v38
  v_fma_f32 v129, v129, s64, v38
  v_mfma_f32_16x16x32_bf16 v[116:119], v[184:187], v[172:175], v[116:119]
  v_fma_f32 v130, v130, s64, v38
  v_fma_f32 v131, v131, s64, v38
  v_mfma_f32_16x16x32_bf16 v[120:123], v[188:191], v[168:171], v[120:123]
  v_fma_f32 v132, v132, s64, v38
  v_fma_f32 v133, v133, s64, v38
  v_mfma_f32_16x16x32_bf16 v[124:127], v[188:191], v[172:175], v[124:127]
  v_fma_f32 v134, v134, s64, v38
  v_fma_f32 v135, v135, s64, v38
  s_setprio 0
  v_pk_mul_f32 v[128:129], v[128:129], v[64:65]
  v_pk_mul_f32 v[130:131], v[130:131], v[66:67]
  v_pk_mul_f32 v[132:133], v[132:133], v[68:69]
  v_pk_mul_f32 v[134:135], v[134:135], v[70:71]
  v_exp_f32 v128, v128
  v_exp_f32 v129, v129
  v_exp_f32 v130, v130
  v_exp_f32 v131, v131
  v_exp_f32 v132, v132
  v_exp_f32 v133, v133
  v_exp_f32 v134, v134
  v_exp_f32 v135, v135
  v_pk_add_f32 v[128:129], v[128:129], 1.0 op_sel_hi:[1,0]
  v_pk_add_f32 v[130:131], v[130:131], 1.0 op_sel_hi:[1,0]
  v_pk_add_f32 v[132:133], v[132:133], 1.0 op_sel_hi:[1,0]
  v_pk_add_f32 v[134:135], v[134:135], 1.0 op_sel_hi:[1,0]
  v_rcp_f32 v128, v128
  v_rcp_f32 v129, v129
  v_rcp_f32 v130, v130
  v_rcp_f32 v131, v131
  v_rcp_f32 v132, v132
  v_rcp_f32 v133, v133
  v_rcp_f32 v134, v134
  v_rcp_f32 v135, v135
  v_pk_mul_f32 v[128:129], v[128:129], v[64:65]
  v_pk_mul_f32 v[130:131], v[130:131], v[66:67]
  v_pk_mul_f32 v[132:133], v[132:133], v[68:69]
  v_pk_mul_f32 v[134:135], v[134:135], v[70:71]
  v_cvt_pk_bf16_f32 v64, v128, v129
  v_cvt_pk_bf16_f32 v66, v132, v133
  v_cvt_pk_bf16_f32 v65, v130, v131
  v_cvt_pk_bf16_f32 v67, v134, v135
  v_permlane16_swap_b32 v64, v66
  s_nop 0
  v_permlane16_swap_b32 v65, v67
  buffer_store_dwordx4 v[64:67], v40, s[36:39], s90 offen offset:0 sc1
  v_pk_mul_f32 v[136:137], v[72:73], v[72:73]
  v_pk_mul_f32 v[138:139], v[74:75], v[74:75]
  v_pk_mul_f32 v[140:141], v[76:77], v[76:77]
  v_pk_mul_f32 v[142:143], v[78:79], v[78:79]
  v_pk_fma_f32 v[136:137], v[136:137], s[64:65], v[38:39]
  v_pk_fma_f32 v[138:139], v[138:139], s[64:65], v[38:39]
  v_pk_fma_f32 v[140:141], v[140:141], s[64:65], v[38:39]
  v_pk_fma_f32 v[142:143], v[142:143], s[64:65], v[38:39]
  v_pk_mul_f32 v[136:137], v[136:137], v[72:73]
  v_pk_mul_f32 v[138:139], v[138:139], v[74:75]
  v_pk_mul_f32 v[140:141], v[140:141], v[76:77]
  v_pk_mul_f32 v[142:143], v[142:143], v[78:79]
  v_exp_f32 v136, v136
  v_exp_f32 v137, v137
  v_exp_f32 v138, v138
  v_exp_f32 v139, v139
  v_exp_f32 v140, v140
  v_exp_f32 v141, v141
  v_exp_f32 v142, v142
  v_exp_f32 v143, v143
  v_pk_add_f32 v[136:137], v[136:137], 1.0 op_sel_hi:[1,0]
  v_pk_add_f32 v[138:139], v[138:139], 1.0 op_sel_hi:[1,0]
  v_pk_add_f32 v[140:141], v[140:141], 1.0 op_sel_hi:[1,0]
  v_pk_add_f32 v[142:143], v[142:143], 1.0 op_sel_hi:[1,0]
  v_rcp_f32 v136, v136
  v_rcp_f32 v137, v137
  v_rcp_f32 v138, v138
  v_rcp_f32 v139, v139
  v_rcp_f32 v140, v140
  v_rcp_f32 v141, v141
  v_rcp_f32 v142, v142
  v_rcp_f32 v143, v143
  v_pk_mul_f32 v[136:137], v[136:137], v[72:73]
  v_pk_mul_f32 v[138:139], v[138:139], v[74:75]
  v_pk_mul_f32 v[140:141], v[140:141], v[76:77]
  v_pk_mul_f32 v[142:143], v[142:143], v[78:79]
  v_cvt_pk_bf16_f32 v72, v136, v137
  v_cvt_pk_bf16_f32 v74, v140, v141
  v_cvt_pk_bf16_f32 v73, v138, v139
  v_cvt_pk_bf16_f32 v75, v142, v143
  v_permlane16_swap_b32 v72, v74
  s_nop 0
  v_permlane16_swap_b32 v73, v75
  buffer_store_dwordx4 v[72:75], v40, s[36:39], s90 offen offset:1024 sc1
  v_pk_mul_f32 v[128:129], v[80:81], v[80:81]
  v_pk_mul_f32 v[130:131], v[82:83], v[82:83]
  v_pk_mul_f32 v[132:133], v[84:85], v[84:85]
  v_pk_mul_f32 v[134:135], v[86:87], v[86:87]
  v_pk_fma_f32 v[128:129], v[128:129], s[64:65], v[38:39]
  v_pk_fma_f32 v[130:131], v[130:131], s[64:65], v[38:39]
  v_pk_fma_f32 v[132:133], v[132:133], s[64:65], v[38:39]
  v_pk_fma_f32 v[134:135], v[134:135], s[64:65], v[38:39]
  v_pk_mul_f32 v[128:129], v[128:129], v[80:81]
  v_pk_mul_f32 v[130:131], v[130:131], v[82:83]
  v_pk_mul_f32 v[132:133], v[132:133], v[84:85]
  v_pk_mul_f32 v[134:135], v[134:135], v[86:87]
  v_exp_f32 v128, v128
  v_exp_f32 v129, v129
  v_exp_f32 v130, v130
  v_exp_f32 v131, v131
  v_exp_f32 v132, v132
  v_exp_f32 v133, v133
  v_exp_f32 v134, v134
  v_exp_f32 v135, v135
  v_pk_add_f32 v[128:129], v[128:129], 1.0 op_sel_hi:[1,0]
  v_pk_add_f32 v[130:131], v[130:131], 1.0 op_sel_hi:[1,0]
  v_pk_add_f32 v[132:133], v[132:133], 1.0 op_sel_hi:[1,0]
  v_pk_add_f32 v[134:135], v[134:135], 1.0 op_sel_hi:[1,0]
  v_rcp_f32 v128, v128
  v_rcp_f32 v129, v129
  v_rcp_f32 v130, v130
  v_rcp_f32 v131, v131
  v_rcp_f32 v132, v132
  v_rcp_f32 v133, v133
  v_rcp_f32 v134, v134
  v_rcp_f32 v135, v135
  v_pk_mul_f32 v[128:129], v[128:129], v[80:81]
  v_pk_mul_f32 v[130:131], v[130:131], v[82:83]
  v_pk_mul_f32 v[132:133], v[132:133], v[84:85]
  v_pk_mul_f32 v[134:135], v[134:135], v[86:87]
  v_cvt_pk_bf16_f32 v80, v128, v129
  v_cvt_pk_bf16_f32 v82, v132, v133
  v_cvt_pk_bf16_f32 v81, v130, v131
  v_cvt_pk_bf16_f32 v83, v134, v135
  v_permlane16_swap_b32 v80, v82
  s_nop 0
  v_permlane16_swap_b32 v81, v83
  buffer_store_dwordx4 v[80:83], v40, s[36:39], s90 offen offset:2048 sc1
  v_pk_mul_f32 v[136:137], v[88:89], v[88:89]
  v_pk_mul_f32 v[138:139], v[90:91], v[90:91]
  v_pk_mul_f32 v[140:141], v[92:93], v[92:93]
  v_pk_mul_f32 v[142:143], v[94:95], v[94:95]
  v_pk_fma_f32 v[136:137], v[136:137], s[64:65], v[38:39]
  v_pk_fma_f32 v[138:139], v[138:139], s[64:65], v[38:39]
  v_pk_fma_f32 v[140:141], v[140:141], s[64:65], v[38:39]
  v_pk_fma_f32 v[142:143], v[142:143], s[64:65], v[38:39]
  v_pk_mul_f32 v[136:137], v[136:137], v[88:89]
  v_pk_mul_f32 v[138:139], v[138:139], v[90:91]
  v_pk_mul_f32 v[140:141], v[140:141], v[92:93]
  v_pk_mul_f32 v[142:143], v[142:143], v[94:95]
  v_exp_f32 v136, v136
  v_exp_f32 v137, v137
  v_exp_f32 v138, v138
  v_exp_f32 v139, v139
  v_exp_f32 v140, v140
  v_exp_f32 v141, v141
  v_exp_f32 v142, v142
  v_exp_f32 v143, v143
  v_pk_add_f32 v[136:137], v[136:137], 1.0 op_sel_hi:[1,0]
  v_pk_add_f32 v[138:139], v[138:139], 1.0 op_sel_hi:[1,0]
  v_pk_add_f32 v[140:141], v[140:141], 1.0 op_sel_hi:[1,0]
  v_pk_add_f32 v[142:143], v[142:143], 1.0 op_sel_hi:[1,0]
  v_rcp_f32 v136, v136
  v_rcp_f32 v137, v137
  v_rcp_f32 v138, v138
  v_rcp_f32 v139, v139
  v_rcp_f32 v140, v140
  v_rcp_f32 v141, v141
  v_rcp_f32 v142, v142
  v_rcp_f32 v143, v143
  v_pk_mul_f32 v[136:137], v[136:137], v[88:89]
  v_pk_mul_f32 v[138:139], v[138:139], v[90:91]
  v_pk_mul_f32 v[140:141], v[140:141], v[92:93]
  v_pk_mul_f32 v[142:143], v[142:143], v[94:95]
  v_cvt_pk_bf16_f32 v88, v136, v137
  v_cvt_pk_bf16_f32 v90, v140, v141
  v_cvt_pk_bf16_f32 v89, v138, v139
  v_cvt_pk_bf16_f32 v91, v142, v143
  v_permlane16_swap_b32 v88, v90
  s_nop 0
  v_permlane16_swap_b32 v89, v91
  buffer_store_dwordx4 v[88:91], v40, s[36:39], s90 offen offset:3072 sc1
  v_pk_mul_f32 v[128:129], v[96:97], v[96:97]
  v_pk_mul_f32 v[130:131], v[98:99], v[98:99]
  v_pk_mul_f32 v[132:133], v[100:101], v[100:101]
  v_pk_mul_f32 v[134:135], v[102:103], v[102:103]
  v_pk_fma_f32 v[128:129], v[128:129], s[64:65], v[38:39]
  v_pk_fma_f32 v[130:131], v[130:131], s[64:65], v[38:39]
  v_pk_fma_f32 v[132:133], v[132:133], s[64:65], v[38:39]
  v_pk_fma_f32 v[134:135], v[134:135], s[64:65], v[38:39]
  v_pk_mul_f32 v[128:129], v[128:129], v[96:97]
  v_pk_mul_f32 v[130:131], v[130:131], v[98:99]
  v_pk_mul_f32 v[132:133], v[132:133], v[100:101]
  v_pk_mul_f32 v[134:135], v[134:135], v[102:103]
  v_exp_f32 v128, v128
  v_exp_f32 v129, v129
  v_exp_f32 v130, v130
  v_exp_f32 v131, v131
  v_exp_f32 v132, v132
  v_exp_f32 v133, v133
  v_exp_f32 v134, v134
  v_exp_f32 v135, v135
  v_pk_add_f32 v[128:129], v[128:129], 1.0 op_sel_hi:[1,0]
  v_pk_add_f32 v[130:131], v[130:131], 1.0 op_sel_hi:[1,0]
  v_pk_add_f32 v[132:133], v[132:133], 1.0 op_sel_hi:[1,0]
  v_pk_add_f32 v[134:135], v[134:135], 1.0 op_sel_hi:[1,0]
  ds_write_b32 v15, v19 offset:48
  v_rcp_f32 v128, v128
  v_rcp_f32 v129, v129
  v_rcp_f32 v130, v130
  v_rcp_f32 v131, v131
  v_rcp_f32 v132, v132
  v_rcp_f32 v133, v133
  v_rcp_f32 v134, v134
  v_rcp_f32 v135, v135
  v_mul_f32 v128, v128, v96
  v_mul_f32 v129, v129, v97
  v_mul_f32 v130, v130, v98
  v_mul_f32 v131, v131, v99
  v_mul_f32 v132, v132, v100
  v_mul_f32 v133, v133, v101
  v_mul_f32 v134, v134, v102
  v_mul_f32 v135, v135, v103
  v_cvt_pk_bf16_f32 v96, v128, v129
  v_cvt_pk_bf16_f32 v98, v132, v133
  v_cvt_pk_bf16_f32 v97, v130, v131
  v_cvt_pk_bf16_f32 v99, v134, v135
  v_permlane16_swap_b32 v96, v98
  s_nop 0
  v_permlane16_swap_b32 v97, v99
  buffer_store_dwordx4 v[96:99], v41, s[36:39], s90 offen offset:0 sc1
  v_mul_f32 v136, v104, v104
  v_mul_f32 v137, v105, v105
  v_mul_f32 v138, v106, v106
  v_mul_f32 v139, v107, v107
  v_mul_f32 v140, v108, v108
  v_mul_f32 v141, v109, v109
  v_mul_f32 v142, v110, v110
  v_mul_f32 v143, v111, v111
  v_fma_f32 v136, v136, s64, v38
  v_fma_f32 v137, v137, s64, v38
  v_fma_f32 v138, v138, s64, v38
  v_fma_f32 v139, v139, s64, v38
  v_fma_f32 v140, v140, s64, v38
  v_fma_f32 v141, v141, s64, v38
  v_fma_f32 v142, v142, s64, v38
  v_fma_f32 v143, v143, s64, v38
  v_mul_f32 v136, v136, v104
  v_mul_f32 v137, v137, v105
  v_mul_f32 v138, v138, v106
  v_mul_f32 v139, v139, v107
  v_mul_f32 v140, v140, v108
  v_mul_f32 v141, v141, v109
  v_mul_f32 v142, v142, v110
  v_mul_f32 v143, v143, v111
  v_exp_f32 v136, v136
  v_exp_f32 v137, v137
  v_exp_f32 v138, v138
  v_exp_f32 v139, v139
  v_exp_f32 v140, v140
  v_exp_f32 v141, v141
  v_exp_f32 v142, v142
  v_exp_f32 v143, v143
  s_waitcnt vmcnt(1)
  s_mov_b64 exec, 1
  buffer_store_dword v2, off, s[36:39], s100 sc1
  s_mov_b64 exec, -1
  s_add_u32 s100, s100, 128
  v_add_f32 v136, 1.0, v136
  v_add_f32 v137, 1.0, v137
  v_add_f32 v138, 1.0, v138
  v_add_f32 v139, 1.0, v139
  v_add_f32 v140, 1.0, v140
  v_add_f32 v141, 1.0, v141
  v_add_f32 v142, 1.0, v142
  v_add_f32 v143, 1.0, v143
  v_rcp_f32 v136, v136
  v_rcp_f32 v137, v137
  v_rcp_f32 v138, v138
  v_rcp_f32 v139, v139
  v_rcp_f32 v140, v140
  v_rcp_f32 v141, v141
  v_rcp_f32 v142, v142
  v_rcp_f32 v143, v143
  v_mul_f32 v136, v136, v104
  v_mul_f32 v137, v137, v105
  v_mul_f32 v138, v138, v106
  v_mul_f32 v139, v139, v107
  v_mul_f32 v140, v140, v108
  v_mul_f32 v141, v141, v109
  v_mul_f32 v142, v142, v110
  v_mul_f32 v143, v143, v111
  v_cvt_pk_bf16_f32 v104, v136, v137
  v_cvt_pk_bf16_f32 v106, v140, v141
  v_cvt_pk_bf16_f32 v105, v138, v139
  v_cvt_pk_bf16_f32 v107, v142, v143
  v_permlane16_swap_b32 v104, v106
  s_nop 0
  v_permlane16_swap_b32 v105, v107
  buffer_store_dwordx4 v[104:107], v41, s[36:39], s90 offen offset:1024 sc1
  v_mul_f32 v128, v112, v112
  v_mul_f32 v129, v113, v113
  v_mul_f32 v130, v114, v114
  v_mul_f32 v131, v115, v115
  v_mul_f32 v132, v116, v116
  v_mul_f32 v133, v117, v117
  v_mul_f32 v134, v118, v118
  v_mul_f32 v135, v119, v119
  v_fma_f32 v128, v128, s64, v38
  v_fma_f32 v129, v129, s64, v38
  v_fma_f32 v130, v130, s64, v38
  v_fma_f32 v131, v131, s64, v38
  v_fma_f32 v132, v132, s64, v38
  v_fma_f32 v133, v133, s64, v38
  v_fma_f32 v134, v134, s64, v38
  v_fma_f32 v135, v135, s64, v38
  v_mul_f32 v128, v128, v112
  v_mul_f32 v129, v129, v113
  v_mul_f32 v130, v130, v114
L_stub3:
  s_cbranch_execz L_stub4
  v_mul_f32 v131, v131, v115
  v_mul_f32 v132, v132, v116
  v_mul_f32 v133, v133, v117
  v_mul_f32 v134, v134, v118
  v_mul_f32 v135, v135, v119
  v_exp_f32 v128, v128
  v_exp_f32 v129, v129
  v_exp_f32 v130, v130
  v_exp_f32 v131, v131
  v_exp_f32 v132, v132
  v_exp_f32 v133, v133
  v_exp_f32 v134, v134
  v_exp_f32 v135, v135
  v_add_f32 v128, 1.0, v128
  v_add_f32 v129, 1.0, v129
  v_add_f32 v130, 1.0, v130
  v_add_f32 v131, 1.0, v131
  v_add_f32 v132, 1.0, v132
  v_add_f32 v133, 1.0, v133
  v_add_f32 v134, 1.0, v134
  v_add_f32 v135, 1.0, v135
  v_rcp_f32 v128, v128
  v_rcp_f32 v129, v129
  v_rcp_f32 v130, v130
  v_rcp_f32 v131, v131
  v_rcp_f32 v132, v132
  v_rcp_f32 v133, v133
  v_rcp_f32 v134, v134
  v_rcp_f32 v135, v135
  v_mul_f32 v128, v128, v112
  v_mul_f32 v129, v129, v113
  v_mul_f32 v130, v130, v114
  v_mul_f32 v131, v131, v115
  v_mul_f32 v132, v132, v116
  v_mul_f32 v133, v133, v117
  v_mul_f32 v134, v134, v118
  v_mul_f32 v135, v135, v119
  v_cvt_pk_bf16_f32 v112, v128, v129
  v_cvt_pk_bf16_f32 v114, v132, v133
  v_cvt_pk_bf16_f32 v113, v130, v131
  v_cvt_pk_bf16_f32 v115, v134, v135
  v_permlane16_swap_b32 v112, v114
  s_nop 0
  v_permlane16_swap_b32 v113, v115
  buffer_store_dwordx4 v[112:115], v41, s[36:39], s90 offen offset:2048 sc1
  v_mul_f32 v136, v120, v120
  v_mul_f32 v137, v121, v121
  v_mul_f32 v138, v122, v122
  v_mul_f32 v139, v123, v123
  v_mul_f32 v140, v124, v124
  v_mul_f32 v141, v125, v125
  v_mul_f32 v142, v126, v126
  v_mul_f32 v143, v127, v127
  v_fma_f32 v136, v136, s64, v38
  v_fma_f32 v137, v137, s64, v38
  v_fma_f32 v138, v138, s64, v38
  v_fma_f32 v139, v139, s64, v38
  v_fma_f32 v140, v140, s64, v38
  v_fma_f32 v141, v141, s64, v38
  v_fma_f32 v142, v142, s64, v38
  v_fma_f32 v143, v143, s64, v38
  v_mul_f32 v136, v136, v120
  v_mul_f32 v137, v137, v121
  v_mul_f32 v138, v138, v122
  v_mul_f32 v139, v139, v123
  v_mul_f32 v140, v140, v124
  v_mul_f32 v141, v141, v125
  v_mul_f32 v142, v142, v126
  v_mul_f32 v143, v143, v127
  v_exp_f32 v136, v136
  v_exp_f32 v137, v137
  v_exp_f32 v138, v138
  v_exp_f32 v139, v139
  v_exp_f32 v140, v140
  v_exp_f32 v141, v141
  v_exp_f32 v142, v142
  v_exp_f32 v143, v143
  v_add_f32 v136, 1.0, v136
  v_add_f32 v137, 1.0, v137
  v_add_f32 v138, 1.0, v138
  v_add_f32 v139, 1.0, v139
  v_add_f32 v140, 1.0, v140
  v_add_f32 v141, 1.0, v141
  v_add_f32 v142, 1.0, v142
  v_add_f32 v143, 1.0, v143
  v_rcp_f32 v136, v136
  v_rcp_f32 v137, v137
  v_rcp_f32 v138, v138
  v_rcp_f32 v139, v139
  v_rcp_f32 v140, v140
  v_rcp_f32 v141, v141
  v_rcp_f32 v142, v142
  v_rcp_f32 v143, v143
  v_mul_f32 v136, v136, v120
  v_mul_f32 v137, v137, v121
  v_mul_f32 v138, v138, v122
  v_mul_f32 v139, v139, v123
  v_mul_f32 v140, v140, v124
  v_mul_f32 v141, v141, v125
  v_mul_f32 v142, v142, v126
  v_mul_f32 v143, v143, v127
  v_cvt_pk_bf16_f32 v120, v136, v137
  v_cvt_pk_bf16_f32 v122, v140, v141
  v_cvt_pk_bf16_f32 v121, v138, v139
  v_cvt_pk_bf16_f32 v123, v142, v143
  v_permlane16_swap_b32 v120, v122
  s_nop 0
  v_permlane16_swap_b32 v121, v123
  buffer_store_dwordx4 v[120:123], v41, s[36:39], s90 offen offset:3072 sc1
  s_load_dwordx8 s[12:19], s[36:37], s62 glc
  v_lshlrev_b32 v224, 16, v48
  v_and_b32 v225, 0xffff0000, v48
  v_lshlrev_b32 v226, 16, v49
  v_and_b32 v227, 0xffff0000, v49
  v_lshlrev_b32 v228, 16, v50
  v_and_b32 v229, 0xffff0000, v50
  v_lshlrev_b32 v230, 16, v51
  v_and_b32 v231, 0xffff0000, v51
  v_lshlrev_b32 v232, 16, v52
  v_and_b32 v233, 0xffff0000, v52
  v_lshlrev_b32 v234, 16, v53
  v_and_b32 v235, 0xffff0000, v53
  v_lshlrev_b32 v236, 16, v54
  v_and_b32 v237, 0xffff0000, v54
  v_lshlrev_b32 v238, 16, v55
  v_and_b32 v239, 0xffff0000, v55
  s_mov_b32 s85, 0
  s_branch L_c_ph0
L_rt_ph0:
  s_sleep 1
  s_add_u32 s85, s85, 1
  s_cmp_gt_u32 s85, 0x40000
  s_cbranch_scc1 L_ok_ph0
  s_load_dwordx8 s[12:19], s[36:37], s62 glc
L_c_ph0:
  s_waitcnt lgkmcnt(0)
  s_cmp_lg_u64 s[12:13], s[82:83]
  s_cbranch_scc1 L_rt_ph0
  s_cmp_lg_u64 s[14:15], s[82:83]
  s_cbranch_scc1 L_rt_ph0
  s_cmp_lg_u64 s[16:17], s[82:83]
  s_cbranch_scc1 L_rt_ph0
  s_cmp_lg_u32 s18, s82
  s_cbranch_scc1 L_rt_ph0
L_ok_ph0:
  buffer_load_dwordx4 v[68:71], v40, s[36:39], s91 offen offset:0 sc1
  buffer_load_dwordx4 v[76:79], v40, s[36:39], s91 offen offset:1024 sc1
  buffer_load_dwordx4 v[84:87], v40, s[36:39], s91 offen offset:2048 sc1
  buffer_load_dwordx4 v[92:95], v40, s[36:39], s91 offen offset:3072 sc1
  buffer_load_dwordx4 v[100:103], v40, s[36:39], s92 offen offset:0 sc1
  buffer_load_dwordx4 v[108:111], v40, s[36:39], s92 offen offset:1024 sc1
  buffer_load_dwordx4 v[116:119], v40, s[36:39], s92 offen offset:2048 sc1
  buffer_load_dwordx4 v[124:127], v40, s[36:39], s92 offen offset:3072 sc1
  s_waitcnt vmcnt(8)
  s_mov_b64 exec, 1
  buffer_store_dword v2, off, s[36:39], s100 sc1
  s_mov_b64 exec, -1
  s_setprio 2
  s_mov_b32 s85, 0
L_rt_lwa:
  ds_read_b32 v17, v16 offset:144
  ds_read_b64_tr_b16 v[128:129], v26 offset:32768
  ds_read_b64_tr_b16 v[130:131], v26 offset:33792
  ds_read_b64_tr_b16 v[132:133], v27 offset:32768
  ds_read_b64_tr_b16 v[134:135], v27 offset:33792
  ds_read_b64_tr_b16 v[136:137], v26 offset:34816
  ds_read_b64_tr_b16 v[138:139], v26 offset:35840
  ds_read_b64_tr_b16 v[140:141], v27 offset:34816
  ds_read_b64_tr_b16 v[142:143], v27 offset:35840
  ds_read_b64_tr_b16 v[144:145], v26 offset:36864
  ds_read_b64_tr_b16 v[146:147], v26 offset:37888
  ds_read_b64_tr_b16 v[148:149], v27 offset:36864
  ds_read_b64_tr_b16 v[150:151], v27 offset:37888
  ds_read_b64_tr_b16 v[152:153], v26 offset:38912
  ds_read_b64_tr_b16 v[154:155], v26 offset:39936
  ds_read_b64_tr_b16 v[156:157], v27 offset:38912
  ds_read_b64_tr_b16 v[158:159], v27 offset:39936
  s_waitcnt lgkmcnt(15)
  v_cmp_eq_u32 vcc, 0, v17
  s_nop 0
  s_cbranch_vccz L_ok_lwa
  s_sleep 1
  s_add_u32 s85, s85, 1
  s_cmp_lt_u32 s85, 0x400000
  s_cbranch_scc1 L_rt_lwa
L_ok_lwa:
  s_waitcnt lgkmcnt(14)
  v_mfma_f32_32x32x16_bf16 v[176:191], v[128:131], v[64:67], 0
  v_mfma_f32_32x32x16_bf16 v[208:223], v[128:131], v[96:99], 0
  buffer_load_dwordx4 v[240:243], v40, s[36:39], s93 offen offset:0 sc1
  ds_read_b64_tr_b16 v[160:161], v24 offset:0
  ds_read_b64_tr_b16 v[162:163], v24 offset:1024
  s_waitcnt lgkmcnt(14)
  v_mfma_f32_32x32x16_bf16 v[192:207], v[132:135], v[64:67], 0
  v_mfma_f32_32x32x16_bf16 v[224:239], v[132:135], v[96:99], v[224:239]
  ds_read_b64_tr_b16 v[164:165], v25 offset:0
  ds_read_b64_tr_b16 v[166:167], v25 offset:1024
  s_waitcnt lgkmcnt(14)
  v_mfma_f32_32x32x16_bf16 v[176:191], v[136:139], v[72:75], v[176:191]
  v_mfma_f32_32x32x16_bf16 v[208:223], v[136:139], v[104:107], v[208:223]
  buffer_load_dwordx4 v[244:247], v40, s[36:39], s93 offen offset:1024 sc1
  ds_read_b64_tr_b16 v[168:169], v24 offset:2048
  ds_read_b64_tr_b16 v[170:171], v24 offset:3072
  s_waitcnt lgkmcnt(14)
  v_mfma_f32_32x32x16_bf16 v[192:207], v[140:143], v[72:75], v[192:207]
  v_mfma_f32_32x32x16_bf16 v[224:239], v[140:143], v[104:107], v[224:239]
  ds_read_b64_tr_b16 v[172:173], v25 offset:2048
  ds_read_b64_tr_b16 v[174:175], v25 offset:3072
  s_waitcnt lgkmcnt(14)
  v_mfma_f32_32x32x16_bf16 v[176:191], v[144:147], v[80:83], v[176:191]
  v_mfma_f32_32x32x16_bf16 v[208:223], v[144:147], v[112:115], v[208:223]
  buffer_load_dwordx4 v[248:251], v40, s[36:39], s93 offen offset:2048 sc1
  ds_read_b64_tr_b16 v[128:129], v24 offset:4096
  ds_read_b64_tr_b16 v[130:131], v24 offset:5120
  s_waitcnt lgkmcnt(14)
  v_mfma_f32_32x32x16_bf16 v[192:207], v[148:151], v[80:83], v[192:207]
  v_mfma_f32_32x32x16_bf16 v[224:239], v[148:151], v[112:115], v[224:239]
  ds_read_b64_tr_b16 v[132:133], v25 offset:4096
  ds_read_b64_tr_b16 v[134:135], v25 offset:5120
  s_waitcnt lgkmcnt(14)
  v_mfma_f32_32x32x16_bf16 v[176:191], v[152:155], v[88:91], v[176:191]
  v_mfma_f32_32x32x16_bf16 v[208:223], v[152:155], v[120:123], v[208:223]
  buffer_load_dwordx4 v[252:255], v40, s[36:39], s93 offen offset:3072 sc1
  ds_read_b64_tr_b16 v[136:137], v24 offset:6144
  ds_read_b64_tr_b16 v[138:139], v24 offset:7168
  s_waitcnt lgkmcnt(14)
  v_mfma_f32_32x32x16_bf16 v[192:207], v[156:159], v[88:91], v[192:207]
  v_mfma_f32_32x32x16_bf16 v[224:239], v[156:159], v[120:123], v[224:239]
  s_nop 5
  v_cvt_pk_f16_f32 v96, v208, v209
  v_cvt_pk_f16_f32 v97, v210, v211
  v_cvt_pk_f16_f32 v98, v212, v213
  v_cvt_pk_f16_f32 v99, v214, v215
  v_cvt_pk_f16_f32 v104, v216, v217
  v_cvt_pk_f16_f32 v105, v218, v219
  v_cvt_pk_f16_f32 v106, v220, v221
  v_cvt_pk_f16_f32 v107, v222, v223
  v_cvt_pk_f16_f32 v112, v224, v225
  v_cvt_pk_f16_f32 v113, v226, v227
  v_cvt_pk_f16_f32 v114, v228, v229
  v_cvt_pk_f16_f32 v115, v230, v231
  v_cvt_pk_f16_f32 v120, v232, v233
  v_cvt_pk_f16_f32 v121, v234, v235
  v_cvt_pk_f16_f32 v122, v236, v237
  v_cvt_pk_f16_f32 v123, v238, v239
  ds_read_b64_tr_b16 v[140:141], v25 offset:6144
  ds_read_b64_tr_b16 v[142:143], v25 offset:7168
  s_waitcnt vmcnt(12)
  s_waitcnt lgkmcnt(14)
  v_mfma_f32_32x32x16_bf16 v[176:191], v[160:163], v[68:71], v[176:191]
  buffer_load_dwordx4 v[208:211], v40, s[36:39], s94 offen offset:0 sc1
  ds_read_b64_tr_b16 v[144:145], v24 offset:16384
  ds_read_b64_tr_b16 v[146:147], v24 offset:17408
  s_waitcnt lgkmcnt(14)
  v_mfma_f32_32x32x16_bf16 v[192:207], v[164:167], v[68:71], v[192:207]
  buffer_load_dwordx4 v[212:215], v40, s[36:39], s94 offen offset:1024 sc1
  ds_read_b64_tr_b16 v[148:149], v25 offset:16384
  ds_read_b64_tr_b16 v[150:151], v25 offset:17408
  s_waitcnt vmcnt(13)
  s_waitcnt lgkmcnt(14)
  v_mfma_f32_32x32x16_bf16 v[176:191], v[168:171], v[76:79], v[176:191]
  buffer_load_dwordx4 v[216:219], v40, s[36:39], s94 offen offset:2048 sc1
  ds_read_b64_tr_b16 v[152:153], v24 offset:18432
  ds_read_b64_tr_b16 v[154:155], v24 offset:19456
  s_waitcnt lgkmcnt(14)
  v_mfma_f32_32x32x16_bf16 v[192:207], v[172:175], v[76:79], v[192:207]
  buffer_load_dwordx4 v[220:223], v40, s[36:39], s94 offen offset:3072 sc1
  ds_read_b64_tr_b16 v[156:157], v25 offset:18432
  ds_read_b64_tr_b16 v[158:159], v25 offset:19456
  s_waitcnt vmcnt(14)
  s_waitcnt lgkmcnt(14)
  v_mfma_f32_32x32x16_bf16 v[176:191], v[128:131], v[84:87], v[176:191]
  ds_read_b32 v17, v16 offset:64
  buffer_load_dwordx4 v[224:227], v40, s[36:39], s95 offen offset:0 sc1
  ds_read_b64_tr_b16 v[160:161], v24 offset:20480
  ds_read_b64_tr_b16 v[162:163], v24 offset:21504
  s_waitcnt lgkmcnt(15)
  v_mfma_f32_32x32x16_bf16 v[192:207], v[132:135], v[84:87], v[192:207]
  buffer_load_dwordx4 v[228:231], v40, s[36:39], s95 offen offset:1024 sc1
  ds_read_b64_tr_b16 v[164:165], v25 offset:20480
  ds_read_b64_tr_b16 v[166:167], v25 offset:21504
  s_waitcnt vmcnt(15)
  s_waitcnt lgkmcnt(15)
  v_mfma_f32_32x32x16_bf16 v[176:191], v[136:139], v[92:95], v[176:191]
  s_waitcnt lgkmcnt(4)
  v_cmp_eq_u32 vcc, 0, v17
  s_nop 0
  s_cbranch_vccnz L_spin_lya
L_ok_lya:
  ds_write_b128 v44, v[96:99] offset:0
  ds_write_b128 v44, v[104:107] offset:1024
  ds_write_b32 v15, v19 offset:176
  buffer_load_dwordx4 v[232:235], v40, s[36:39], s95 offen offset:2048 sc1
  ds_read_b64_tr_b16 v[168:169], v24 offset:22528
  ds_read_b64_tr_b16 v[170:171], v24 offset:23552
  v_mfma_f32_32x32x16_bf16 v[192:207], v[140:143], v[92:95], v[192:207]
  buffer_load_dwordx4 v[236:239], v40, s[36:39], s95 offen offset:3072 sc1
  ds_read_b64_tr_b16 v[172:173], v25 offset:22528
  ds_read_b64_tr_b16 v[174:175], v25 offset:23552
  s_waitcnt vmcnt(16)
  v_mfma_f32_32x32x16_bf16 v[176:191], v[144:147], v[100:103], v[176:191]
  buffer_load_dwordx4 v[80:83], v40, s[36:39], s96 offen offset:0 sc1
  ds_read_b64_tr_b16 v[128:129], v24 offset:32768
  ds_read_b64_tr_b16 v[130:131], v24 offset:33792
  v_mfma_f32_32x32x16_bf16 v[192:207], v[148:151], v[100:103], v[192:207]
  buffer_load_dwordx4 v[88:91], v40, s[36:39], s96 offen offset:1024 sc1
  ds_read_b64_tr_b16 v[132:133], v25 offset:32768
  ds_read_b64_tr_b16 v[134:135], v25 offset:33792
  s_waitcnt vmcnt(17)
  v_mfma_f32_32x32x16_bf16 v[176:191], v[152:155], v[108:111], v[176:191]
  buffer_load_dwordx4 v[68:71], v40, s[36:39], s96 offen offset:2048 sc1
  ds_read_b64_tr_b16 v[136:137], v24 offset:34816
  ds_read_b64_tr_b16 v[138:139], v24 offset:35840
  v_mfma_f32_32x32x16_bf16 v[192:207], v[156:159], v[108:111], v[192:207]
  buffer_load_dwordx4 v[76:79], v40, s[36:39], s96 offen offset:3072 sc1
  ds_read_b64_tr_b16 v[140:141], v25 offset:34816
  ds_read_b64_tr_b16 v[142:143], v25 offset:35840
  s_waitcnt vmcnt(18)
  s_waitcnt lgkmcnt(15)
  v_mfma_f32_32x32x16_bf16 v[176:191], v[160:163], v[116:119], v[176:191]
  ds_write_b32 v15, v19 offset:208
  ds_read_b64_tr_b16 v[144:145], v24 offset:36864
  ds_read_b64_tr_b16 v[146:147], v24 offset:37888
  v_mfma_f32_32x32x16_bf16 v[192:207], v[164:167], v[116:119], v[192:207]
  ds_read_b32 v17, v16 offset:0
  ds_read_b64_tr_b16 v[148:149], v25 offset:36864
  ds_read_b64_tr_b16 v[150:151], v25 offset:37888
  s_waitcnt vmcnt(17)
  s_waitcnt lgkmcnt(15)
  v_mfma_f32_32x32x16_bf16 v[176:191], v[168:171], v[124:127], v[176:191]
  ds_read_b64_tr_b16 v[152:153], v24 offset:38912
  ds_read_b64_tr_b16 v[154:155], v24 offset:39936
  s_waitcnt lgkmcnt(15)
  v_mfma_f32_32x32x16_bf16 v[192:207], v[172:175], v[124:127], v[192:207]
  s_waitcnt lgkmcnt(4)
  v_cmp_eq_u32 vcc, 0, v17
  s_nop 0
  s_cbranch_vccnz L_spin_lw2
L_ok_lw2:
  ds_read_b64_tr_b16 v[156:157], v25 offset:38912
  ds_read_b64_tr_b16 v[158:159], v25 offset:39936
  s_waitcnt vmcnt(15)
  v_mfma_f32_32x32x16_bf16 v[176:191], v[128:131], v[240:243], v[176:191]
  v_xor_b32 v6, 4, v15
  ds_read_b32 v17, v6 offset:176
  ds_read_b128 v[48:51], v46 offset:0
  ds_read_b128 v[52:55], v46 offset:1024
  ds_read_b64_tr_b16 v[160:161], v24 offset:49152
  ds_read_b64_tr_b16 v[162:163], v24 offset:50176
  v_mfma_f32_32x32x16_bf16 v[192:207], v[132:135], v[240:243], v[192:207]
  ds_read_b64_tr_b16 v[164:165], v25 offset:49152
  ds_read_b64_tr_b16 v[166:167], v25 offset:50176
  s_waitcnt vmcnt(14)
  v_mfma_f32_32x32x16_bf16 v[176:191], v[136:139], v[244:247], v[176:191]
  s_waitcnt lgkmcnt(6)
  v_cmp_eq_u32 vcc, 0, v17
  s_nop 0
  s_cbranch_vccnz L_spin_ls
L_ok_ls:
  ds_read_b64_tr_b16 v[168:169], v24 offset:51200
  ds_read_b64_tr_b16 v[170:171], v24 offset:52224
  v_mfma_f32_32x32x16_bf16 v[192:207], v[140:143], v[244:247], v[192:207]
  s_waitcnt lgkmcnt(6)
  v_pk_add_f16 v48, v48, v112
  v_pk_add_f16 v49, v49, v113
  v_pk_add_f16 v50, v50, v114
  v_pk_add_f16 v51, v51, v115
  ds_read_b64_tr_b16 v[172:173], v25 offset:51200
  ds_read_b64_tr_b16 v[174:175], v25 offset:52224
  s_waitcnt vmcnt(13)
  v_mfma_f32_32x32x16_bf16 v[176:191], v[144:147], v[248:251], v[176:191]
  v_pk_add_f16 v52, v52, v120
  v_pk_add_f16 v53, v53, v121
  v_pk_add_f16 v54, v54, v122
  v_pk_add_f16 v55, v55, v123
  ds_read_b64_tr_b16 v[128:129], v24 offset:53248
  ds_read_b64_tr_b16 v[130:131], v24 offset:54272
  v_mfma_f32_32x32x16_bf16 v[192:207], v[148:151], v[248:251], v[192:207]
  ds_read_b64_tr_b16 v[132:133], v25 offset:53248
  ds_read_b64_tr_b16 v[134:135], v25 offset:54272
  s_waitcnt vmcnt(12)
  v_mfma_f32_32x32x16_bf16 v[176:191], v[152:155], v[252:255], v[176:191]
  ds_read_b64_tr_b16 v[136:137], v24 offset:55296
  ds_read_b64_tr_b16 v[138:139], v24 offset:56320
  v_mfma_f32_32x32x16_bf16 v[192:207], v[156:159], v[252:255], v[192:207]
  ds_read_b64_tr_b16 v[140:141], v25 offset:55296
  ds_read_b64_tr_b16 v[142:143], v25 offset:56320
  s_waitcnt vmcnt(11)
  s_waitcnt lgkmcnt(14)
  v_mfma_f32_32x32x16_bf16 v[176:191], v[160:163], v[208:211], v[176:191]
  ds_read_b64_tr_b16 v[144:145], v26 offset:0
  ds_read_b64_tr_b16 v[146:147], v26 offset:1024
  s_waitcnt lgkmcnt(14)
  v_mfma_f32_32x32x16_bf16 v[192:207], v[164:167], v[208:211], v[192:207]
  ds_read_b64_tr_b16 v[148:149], v27 offset:0
  ds_read_b64_tr_b16 v[150:151], v27 offset:1024
  s_waitcnt vmcnt(10)
  s_waitcnt lgkmcnt(14)
  v_mfma_f32_32x32x16_bf16 v[176:191], v[168:171], v[212:215], v[176:191]
  ds_read_b64_tr_b16 v[152:153], v26 offset:2048
  ds_read_b64_tr_b16 v[154:155], v26 offset:3072
  s_waitcnt lgkmcnt(14)
  v_mfma_f32_32x32x16_bf16 v[192:207], v[172:175], v[212:215], v[192:207]
  ds_read_b64_tr_b16 v[156:157], v27 offset:2048
  ds_read_b64_tr_b16 v[158:159], v27 offset:3072
  s_waitcnt vmcnt(9)
  s_waitcnt lgkmcnt(14)
  v_mfma_f32_32x32x16_bf16 v[176:191], v[128:131], v[216:219], v[176:191]
  ds_read_b64_tr_b16 v[160:161], v26 offset:4096
  ds_read_b64_tr_b16 v[162:163], v26 offset:5120
  s_waitcnt lgkmcnt(14)
  v_mfma_f32_32x32x16_bf16 v[192:207], v[132:135], v[216:219], v[192:207]
  ds_read_b64_tr_b16 v[164:165], v27 offset:4096
  ds_read_b64_tr_b16 v[166:167], v27 offset:5120
  s_waitcnt vmcnt(8)
  s_waitcnt lgkmcnt(14)
  v_mfma_f32_32x32x16_bf16 v[176:191], v[136:139], v[220:223], v[176:191]
  ds_read_b64_tr_b16 v[168:169], v26 offset:6144
  ds_read_b64_tr_b16 v[170:171], v26 offset:7168
  s_waitcnt lgkmcnt(14)
  v_mfma_f32_32x32x16_bf16 v[192:207], v[140:143], v[220:223], v[192:207]
  ds_read_b64_tr_b16 v[172:173], v27 offset:6144
  ds_read_b64_tr_b16 v[174:175], v27 offset:7168
  s_waitcnt vmcnt(7)
  s_waitcnt lgkmcnt(14)
  v_mfma_f32_32x32x16_bf16 v[176:191], v[144:147], v[224:227], v[176:191]
  ds_read_b64_tr_b16 v[128:129], v26 offset:16384
  ds_read_b64_tr_b16 v[130:131], v26 offset:17408
  s_waitcnt lgkmcnt(14)
  v_mfma_f32_32x32x16_bf16 v[192:207], v[148:151], v[224:227], v[192:207]
  ds_read_b64_tr_b16 v[132:133], v27 offset:16384
  ds_read_b64_tr_b16 v[134:135], v27 offset:17408
  s_waitcnt vmcnt(6)
  s_waitcnt lgkmcnt(14)
  v_mfma_f32_32x32x16_bf16 v[176:191], v[152:155], v[228:231], v[176:191]
  ds_read_b64_tr_b16 v[136:137], v26 offset:18432
  ds_read_b64_tr_b16 v[138:139], v26 offset:19456
  s_waitcnt lgkmcnt(14)
  v_mfma_f32_32x32x16_bf16 v[192:207], v[156:159], v[228:231], v[192:207]
  ds_read_b64_tr_b16 v[140:141], v27 offset:18432
  ds_read_b64_tr_b16 v[142:143], v27 offset:19456
  s_waitcnt vmcnt(5)
  s_waitcnt lgkmcnt(14)
  v_mfma_f32_32x32x16_bf16 v[176:191], v[160:163], v[232:235], v[176:191]
  buffer_load_dwordx2 v[4:5], v43, s[36:39], 0 offen sc1
  ds_read_b64_tr_b16 v[144:145], v26 offset:20480
  ds_read_b64_tr_b16 v[146:147], v26 offset:21504
  s_waitcnt lgkmcnt(14)
  v_mfma_f32_32x32x16_bf16 v[192:207], v[164:167], v[232:235], v[192:207]
  ds_read_b64_tr_b16 v[148:149], v27 offset:20480
  ds_read_b64_tr_b16 v[150:151], v27 offset:21504
  s_waitcnt vmcnt(5)
  s_waitcnt lgkmcnt(14)
  v_mfma_f32_32x32x16_bf16 v[176:191], v[168:171], v[236:239], v[176:191]
  ds_read_b64_tr_b16 v[152:153], v26 offset:22528
  ds_read_b64_tr_b16 v[154:155], v26 offset:23552
  s_waitcnt lgkmcnt(14)
  v_mfma_f32_32x32x16_bf16 v[192:207], v[172:175], v[236:239], v[192:207]
  ds_read_b64_tr_b16 v[156:157], v27 offset:22528
  ds_read_b64_tr_b16 v[158:159], v27 offset:23552
  s_waitcnt vmcnt(4)
  s_waitcnt lgkmcnt(14)
  v_mfma_f32_32x32x16_bf16 v[176:191], v[128:131], v[80:83], v[176:191]
  s_waitcnt lgkmcnt(12)
  v_mfma_f32_32x32x16_bf16 v[192:207], v[132:135], v[80:83], v[192:207]
  s_waitcnt vmcnt(3)
  s_waitcnt lgkmcnt(10)
  v_mfma_f32_32x32x16_bf16 v[176:191], v[136:139], v[88:91], v[176:191]
  buffer_load_dwordx4 v[64:67], v42, s[36:39], 0 offen sc1
  buffer_load_dwordx4 v[72:75], v42, s[36:39], s56 offen sc1
  s_waitcnt lgkmcnt(8)
  v_mfma_f32_32x32x16_bf16 v[192:207], v[140:143], v[88:91], v[192:207]
  s_waitcnt vmcnt(4)
  s_waitcnt lgkmcnt(6)
  v_mfma_f32_32x32x16_bf16 v[176:191], v[144:147], v[68:71], v[176:191]
  s_waitcnt lgkmcnt(4)
  v_mfma_f32_32x32x16_bf16 v[192:207], v[148:151], v[68:71], v[192:207]
  s_waitcnt vmcnt(3)
  s_waitcnt lgkmcnt(2)
  v_mfma_f32_32x32x16_bf16 v[176:191], v[152:155], v[76:79], v[176:191]
  s_waitcnt lgkmcnt(0)
  v_mfma_f32_32x32x16_bf16 v[192:207], v[156:159], v[76:79], v[192:207]
  s_setprio 2
  s_nop 8
  v_cvt_pk_f16_f32 v176, v176, v177
  v_cvt_pk_f16_f32 v177, v178, v179
  v_cvt_pk_f16_f32 v178, v180, v181
  v_cvt_pk_f16_f32 v179, v182, v183
  v_cvt_pk_f16_f32 v180, v184, v185
  v_cvt_pk_f16_f32 v181, v186, v187
  v_cvt_pk_f16_f32 v182, v188, v189
  v_cvt_pk_f16_f32 v183, v190, v191
  ds_write_b128 v44, v[176:179] offset:4096
  ds_write_b128 v44, v[180:183] offset:5120
  ds_write_b32 v15, v19 offset:192
  s_mov_b32 s85, 0
L_rt_lp:
  ds_read_b32 v17, v6 offset:192
  ds_read_b128 v[184:187], v46 offset:4096
  ds_read_b128 v[188:191], v46 offset:5120
  s_waitcnt lgkmcnt(2)
  v_cmp_eq_u32 vcc, 0, v17
  s_nop 0
  s_cbranch_vccz L_ok_lp
  s_add_u32 s85, s85, 1
  s_cmp_lt_u32 s85, 0x400000
  s_cbranch_scc1 L_rt_lp
L_ok_lp:
  s_waitcnt lgkmcnt(0)
  v_fma_mix_f32 v192, v184, 1.0, v192 op_sel:[0,0,0] op_sel_hi:[1,0,0]
  v_fma_mix_f32 v193, v184, 1.0, v193 op_sel:[1,0,0] op_sel_hi:[1,0,0]
  v_fma_mix_f32 v194, v185, 1.0, v194 op_sel:[0,0,0] op_sel_hi:[1,0,0]
  v_fma_mix_f32 v195, v185, 1.0, v195 op_sel:[1,0,0] op_sel_hi:[1,0,0]
  v_fma_mix_f32 v196, v186, 1.0, v196 op_sel:[0,0,0] op_sel_hi:[1,0,0]
  v_fma_mix_f32 v197, v186, 1.0, v197 op_sel:[1,0,0] op_sel_hi:[1,0,0]
  v_fma_mix_f32 v198, v187, 1.0, v198 op_sel:[0,0,0] op_sel_hi:[1,0,0]
  v_fma_mix_f32 v199, v187, 1.0, v199 op_sel:[1,0,0] op_sel_hi:[1,0,0]
  v_cvt_pk_f16_f32 v176, v192, v193
  v_cvt_pk_f16_f32 v177, v194, v195
  v_cvt_pk_f16_f32 v178, v196, v197
  v_cvt_pk_f16_f32 v179, v198, v199
  v_bfi_b32 v176, s61, v20, v176
  v_bfi_b32 v177, s61, v21, v177
  v_bfi_b32 v178, s61, v22, v178
  v_bfi_b32 v179, s61, v23, v179
  buffer_store_dwordx4 v[176:179], v18, s[36:39], s57 offen offset:0 sc1
  v_fma_mix_f32 v200, v188, 1.0, v200 op_sel:[0,0,0] op_sel_hi:[1,0,0]
  v_fma_mix_f32 v201, v188, 1.0, v201 op_sel:[1,0,0] op_sel_hi:[1,0,0]
  v_fma_mix_f32 v202, v189, 1.0, v202 op_sel:[0,0,0] op_sel_hi:[1,0,0]
  v_fma_mix_f32 v203, v189, 1.0, v203 op_sel:[1,0,0] op_sel_hi:[1,0,0]
  v_fma_mix_f32 v204, v190, 1.0, v204 op_sel:[0,0,0] op_sel_hi:[1,0,0]
  v_fma_mix_f32 v205, v190, 1.0, v205 op_sel:[1,0,0] op_sel_hi:[1,0,0]
  v_fma_mix_f32 v206, v191, 1.0, v206 op_sel:[0,0,0] op_sel_hi:[1,0,0]
  v_fma_mix_f32 v207, v191, 1.0, v207 op_sel:[1,0,0] op_sel_hi:[1,0,0]
  v_cvt_pk_f16_f32 v180, v200, v201
  v_cvt_pk_f16_f32 v181, v202, v203
  v_cvt_pk_f16_f32 v182, v204, v205
  v_cvt_pk_f16_f32 v183, v206, v207
  v_bfi_b32 v180, s61, v20, v180
  v_bfi_b32 v181, s61, v21, v181
  v_bfi_b32 v182, s61, v22, v182
  v_bfi_b32 v183, s61, v23, v183
  buffer_store_dwordx4 v[180:183], v18, s[36:39], s57 offen offset:1024 sc1
  s_setprio 3
  v_lshlrev_b32 v208, 16, v56
  v_and_b32 v209, 0xffff0000, v56
  v_lshlrev_b32 v210, 16, v57
  v_and_b32 v211, 0xffff0000, v57
  v_lshlrev_b32 v212, 16, v58
  v_and_b32 v213, 0xffff0000, v58
  v_lshlrev_b32 v214, 16, v59
  v_and_b32 v215, 0xffff0000, v59
  v_lshlrev_b32 v216, 16, v60
  v_and_b32 v217, 0xffff0000, v60
  v_lshlrev_b32 v218, 16, v61
  v_and_b32 v219, 0xffff0000, v61
  v_lshlrev_b32 v220, 16, v62
  v_and_b32 v221, 0xffff0000, v62
  v_lshlrev_b32 v222, 16, v63
  v_and_b32 v223, 0xffff0000, v63
  s_waitcnt vmcnt(4)
  v_cmp_ne_u32 vcc, v5, v2
  s_nop 0
  s_cbranch_vccnz L_spin_pg
L_ok_pg:
  v_mul_f32 v208, v208, v4
  v_mul_f32 v209, v209, v4
  v_mul_f32 v210, v210, v4
  v_mul_f32 v211, v211, v4
  v_mul_f32 v212, v212, v4
  v_mul_f32 v213, v213, v4
  v_mul_f32 v214, v214, v4
  v_mul_f32 v215, v215, v4
  v_mul_f32 v216, v216, v4
  v_mul_f32 v217, v217, v4
  v_mul_f32 v218, v218, v4
  v_mul_f32 v219, v219, v4
  v_mul_f32 v220, v220, v4
  v_mul_f32 v221, v221, v4
  v_mul_f32 v222, v222, v4
  v_mul_f32 v223, v223, v4
  v_sub_f32 v4, 1.0, v4
  v_cvt_pk_f16_f32 v56, v208, v209
  v_cvt_pk_f16_f32 v57, v210, v211
  v_cvt_pk_f16_f32 v58, v212, v213
  v_cvt_pk_f16_f32 v59, v214, v215
  v_cvt_pk_f16_f32 v60, v216, v217
  v_cvt_pk_f16_f32 v61, v218, v219
  v_cvt_pk_f16_f32 v62, v220, v221
  v_cvt_pk_f16_f32 v63, v222, v223
  ds_write_b32 v47, v4 offset:6144
  v_fma_mix_f32 v240, v48, v4, 0 op_sel:[0,0,0] op_sel_hi:[1,0,0]
  v_fma_mix_f32 v241, v48, v4, 0 op_sel:[1,0,0] op_sel_hi:[1,0,0]
  v_fma_mix_f32 v242, v49, v4, 0 op_sel:[0,0,0] op_sel_hi:[1,0,0]
  v_fma_mix_f32 v243, v49, v4, 0 op_sel:[1,0,0] op_sel_hi:[1,0,0]
  v_fma_mix_f32 v244, v50, v4, 0 op_sel:[0,0,0] op_sel_hi:[1,0,0]
  v_fma_mix_f32 v245, v50, v4, 0 op_sel:[1,0,0] op_sel_hi:[1,0,0]
  v_fma_mix_f32 v246, v51, v4, 0 op_sel:[0,0,0] op_sel_hi:[1,0,0]
  v_fma_mix_f32 v247, v51, v4, 0 op_sel:[1,0,0] op_sel_hi:[1,0,0]
  v_fma_mix_f32 v248, v52, v4, 0 op_sel:[0,0,0] op_sel_hi:[1,0,0]
  v_fma_mix_f32 v249, v52, v4, 0 op_sel:[1,0,0] op_sel_hi:[1,0,0]
  v_fma_mix_f32 v250, v53, v4, 0 op_sel:[0,0,0] op_sel_hi:[1,0,0]
  v_fma_mix_f32 v251, v53, v4, 0 op_sel:[1,0,0] op_sel_hi:[1,0,0]
  v_fma_mix_f32 v252, v54, v4, 0 op_sel:[0,0,0] op_sel_hi:[1,0,0]
  v_fma_mix_f32 v253, v54, v4, 0 op_sel:[1,0,0] op_sel_hi:[1,0,0]
  v_fma_mix_f32 v254, v55, v4, 0 op_sel:[0,0,0] op_sel_hi:[1,0,0]
  v_fma_mix_f32 v255, v55, v4, 0 op_sel:[1,0,0] op_sel_hi:[1,0,0]
  s_waitcnt vmcnt(2)
  v_xor_b32 v64, v20, v64
  v_xor_b32 v65, v21, v65
  v_xor_b32 v66, v22, v66
  v_xor_b32 v67, v23, v67
  v_xor_b32 v72, v20, v72
  v_xor_b32 v73, v21, v73
  v_xor_b32 v74, v22, v74
  v_xor_b32 v75, v23, v75
  v_or_b32 v12, v64, v65
  v_or3_b32 v12, v12, v66, v67
  v_or3_b32 v12, v12, v72, v73
  v_or3_b32 v12, v12, v74, v75
  v_and_b32 v12, s61, v12
  v_cmp_ne_u32 vcc, 0, v12
  s_nop 0
  s_cbranch_vccnz L_spin_pz
L_ok_pz:
  ds_write_b128 v46, v[64:67] offset:4096
  ds_write_b128 v46, v[72:75] offset:5120
  ds_read_b64_tr_b16 v[224:225], v45 offset:4096
  ds_read_b64_tr_b16 v[226:227], v45 offset:4352
  ds_read_b64_tr_b16 v[228:229], v45 offset:5120
  ds_read_b64_tr_b16 v[230:231], v45 offset:5376
  s_waitcnt lgkmcnt(3)
  v_fma_mix_f32 v240, v224, v56, v240 op_sel:[0,0,0] op_sel_hi:[1,1,0]
  v_fma_mix_f32 v241, v224, v56, v241 op_sel:[1,1,0] op_sel_hi:[1,1,0]
  v_fma_mix_f32 v242, v225, v57, v242 op_sel:[0,0,0] op_sel_hi:[1,1,0]
  v_fma_mix_f32 v243, v225, v57, v243 op_sel:[1,1,0] op_sel_hi:[1,1,0]
  s_waitcnt lgkmcnt(2)
  v_fma_mix_f32 v244, v226, v58, v244 op_sel:[0,0,0] op_sel_hi:[1,1,0]
  v_fma_mix_f32 v245, v226, v58, v245 op_sel:[1,1,0] op_sel_hi:[1,1,0]
  v_fma_mix_f32 v246, v227, v59, v246 op_sel:[0,0,0] op_sel_hi:[1,1,0]
  v_fma_mix_f32 v247, v227, v59, v247 op_sel:[1,1,0] op_sel_hi:[1,1,0]
  s_waitcnt lgkmcnt(1)
  v_fma_mix_f32 v248, v228, v60, v248 op_sel:[0,0,0] op_sel_hi:[1,1,0]
  v_fma_mix_f32 v249, v228, v60, v249 op_sel:[1,1,0] op_sel_hi:[1,1,0]
  v_fma_mix_f32 v250, v229, v61, v250 op_sel:[0,0,0] op_sel_hi:[1,1,0]
  v_fma_mix_f32 v251, v229, v61, v251 op_sel:[1,1,0] op_sel_hi:[1,1,0]
  s_waitcnt lgkmcnt(0)
  v_fma_mix_f32 v252, v230, v62, v252 op_sel:[0,0,0] op_sel_hi:[1,1,0]
  v_fma_mix_f32 v253, v230, v62, v253 op_sel:[1,1,0] op_sel_hi:[1,1,0]
  v_fma_mix_f32 v254, v231, v63, v254 op_sel:[0,0,0] op_sel_hi:[1,1,0]
  v_fma_mix_f32 v255, v231, v63, v255 op_sel:[1,1,0] op_sel_hi:[1,1,0]
  ds_write_b128 v46, v[240:243] offset:0
  ds_write_b128 v46, v[244:247] offset:1024
  ds_write_b128 v46, v[248:251] offset:2048
  ds_write_b128 v46, v[252:255] offset:3072
  ds_write_b32 v15, v19 offset:112
L_stub4:
  s_cbranch_execz L_back
  s_waitcnt lgkmcnt(0)
  s_endpgm
L_spin_lwb:
  s_mov_b32 s85, 0
L_spin2_lwb:
  ds_read_b32 v17, v16 offset:0
  s_add_u32 s85, s85, 1
  s_waitcnt lgkmcnt(0)
  v_cmp_eq_u32 vcc, 0, v17
  s_cmp_gt_u32 s85, 0x400000
  s_cbranch_scc1 L_ok_lwb
  s_cbranch_vccz L_ok_lwb
  s_sleep 1
  s_branch L_spin2_lwb
L_spin_lyb:
  s_mov_b32 s85, 0
L_spin2_lyb:
  ds_read_b32 v17, v48 offset:80
  s_add_u32 s85, s85, 1
  s_waitcnt lgkmcnt(0)
  v_cmp_eq_u32 vcc, 0, v17
  s_cmp_gt_u32 s85, 0x400000
  s_cbranch_scc1 L_ok_lyb
  s_cbranch_vccz L_ok_lyb
  s_sleep 1
  s_branch L_spin2_lyb
L_spin_pp:
  s_mov_b32 s85, 0
L_spin2_pp:
  buffer_load_dwordx4 v[240:243], v18, s[36:39], s60 offen offset:0 sc1
  buffer_load_dwordx4 v[244:247], v18, s[36:39], s60 offen offset:1024 sc1
  s_add_u32 s85, s85, 1
  s_waitcnt vmcnt(0)
  v_xor_b32 v240, v20, v240
  v_xor_b32 v241, v21, v241
  v_xor_b32 v242, v22, v242
  v_xor_b32 v243, v23, v243
  v_xor_b32 v244, v20, v244
  v_xor_b32 v245, v21, v245
  v_xor_b32 v246, v22, v246
  v_xor_b32 v247, v23, v247
  v_or_b32 v12, v240, v241
  v_or3_b32 v12, v12, v242, v243
  v_or3_b32 v12, v12, v244, v245
  v_or3_b32 v12, v12, v246, v247
  v_and_b32 v12, s61, v12
  v_cmp_ne_u32 vcc, 0, v12
  s_cmp_gt_u32 s85, 0x40000
  s_cbranch_scc1 L_ok_pp
  s_cbranch_vccz L_ok_pp
  s_sleep 1
  s_branch L_spin2_pp
L_spin_le:
  s_mov_b32 s85, 0
L_spin2_le:
  ds_read_b32 v17, v15 offset:112
  s_add_u32 s85, s85, 1
  s_waitcnt lgkmcnt(0)
  v_cmp_eq_u32 vcc, 0, v17
  s_cmp_gt_u32 s85, 0x400000
  s_cbranch_scc1 L_post_le
  s_cbranch_vccz L_post_le
  s_sleep 1
  s_branch L_spin2_le
L_post_le:
  ds_read_b32 v4, v51 offset:6144
  ds_read_b128 v[224:227], v46 offset:0
  ds_read_b128 v[228:231], v46 offset:1024
  ds_read_b128 v[232:235], v46 offset:2048
  ds_read_b128 v[236:239], v46 offset:3072
  s_waitcnt lgkmcnt(0)
  s_branch L_ok_le
L_spin_lx:
  s_mov_b32 s85, 0
L_spin2_lx:
  ds_read_b32 v17, v48 offset:96
  s_add_u32 s85, s85, 1
  s_waitcnt lgkmcnt(0)
  v_cmp_eq_u32 vcc, 0, v17
  s_cmp_gt_u32 s85, 0x400000
  s_cbranch_scc1 L_post_lx
  s_cbranch_vccz L_post_lx
  s_sleep 1
  s_branch L_spin2_lx
L_post_lx:
  ds_read_b128 v[128:131], v47 offset:6720
  ds_read_b128 v[132:135], v47 offset:7744
  ds_read_b128 v[136:139], v47 offset:8768
  ds_read_b128 v[140:143], v47 offset:9792
  s_waitcnt lgkmcnt(0)
  s_branch L_ok_lx
L_spin_lya:
  s_mov_b32 s85, 0
L_spin2_lya:
  ds_read_b32 v17, v16 offset:64
  s_add_u32 s85, s85, 1
  s_waitcnt lgkmcnt(0)
  v_cmp_eq_u32 vcc, 0, v17
  s_cmp_gt_u32 s85, 0x400000
  s_cbranch_scc1 L_ok_lya
  s_cbranch_vccz L_ok_lya
  s_sleep 1
  s_branch L_spin2_lya
L_spin_pg:
  s_mov_b32 s85, 0
L_spin2_pg:
  buffer_load_dwordx2 v[4:5], v43, s[36:39], 0 offen sc1
  s_add_u32 s85, s85, 1
  s_waitcnt vmcnt(0)
  v_cmp_ne_u32 vcc, v5, v2
  s_cmp_gt_u32 s85, 0x40000
  s_cbranch_scc1 L_ok_pg
  s_cbranch_vccz L_ok_pg
  s_sleep 1
  s_branch L_spin2_pg
L_spin_ls:
  s_mov_b32 s85, 0
L_spin2_ls:
  ds_read_b32 v17, v6 offset:176
  s_add_u32 s85, s85, 1
  s_waitcnt lgkmcnt(0)
  v_cmp_eq_u32 vcc, 0, v17
  s_cmp_gt_u32 s85, 0x400000
  s_cbranch_scc1 L_post_ls
  s_cbranch_vccz L_post_ls
  s_sleep 1
  s_branch L_spin2_ls
L_post_ls:
  ds_read_b128 v[48:51], v46 offset:0
  ds_read_b128 v[52:55], v46 offset:1024
  s_waitcnt lgkmcnt(0)
  s_branch L_ok_ls
L_spin_lw2:
  s_mov_b32 s85, 0
L_spin2_lw2:
  ds_read_b32 v17, v16 offset:0
  s_add_u32 s85, s85, 1
  s_waitcnt lgkmcnt(0)
  v_cmp_eq_u32 vcc, 0, v17
  s_cmp_gt_u32 s85, 0x400000
  s_cbranch_scc1 L_ok_lw2
  s_cbranch_vccz L_ok_lw2
  s_sleep 1
  s_branch L_spin2_lw2
L_spin_pz:
  s_mov_b32 s85, 0
L_spin2_pz:
  buffer_load_dwordx4 v[64:67], v42, s[36:39], 0 offen sc1
  buffer_load_dwordx4 v[72:75], v42, s[36:39], s56 offen sc1
  s_add_u32 s85, s85, 1
  s_waitcnt vmcnt(0)
  v_xor_b32 v64, v20, v64
  v_xor_b32 v65, v21, v65
  v_xor_b32 v66, v22, v66
  v_xor_b32 v67, v23, v67
  v_xor_b32 v72, v20, v72
  v_xor_b32 v73, v21, v73
  v_xor_b32 v74, v22, v74
  v_xor_b32 v75, v23, v75
  v_or_b32 v12, v64, v65
  v_or3_b32 v12, v12, v66, v67
  v_or3_b32 v12, v12, v72, v73
  v_or3_b32 v12, v12, v74, v75
  v_and_b32 v12, s61, v12
  v_cmp_ne_u32 vcc, 0, v12
  s_cmp_gt_u32 s85, 0x40000
  s_cbranch_scc1 L_ok_pz
  s_cbranch_vccz L_ok_pz
  s_sleep 1
  s_branch L_spin2_pz
L_spare:
  s_cmp_ge_u32 s2, 256
  s_cbranch_scc1 L_end
  s_mov_b32 s10, 0x1c0000
  s_mov_b32 s11, 0x20000
  s_mov_b32 s26, 0x188000
  s_mov_b32 s27, 0x20000
  s_mov_b32 s38, 0x1200000
  s_mov_b32 s39, 0x20000
  s_mov_b32 s30, 0x188000
  s_mov_b32 s31, 0x20000
  s_mov_b32 s22, 0x1c0000
  s_mov_b32 s23, 0x20000
  s_waitcnt lgkmcnt(0)
  s_mov_b64 s[8:9], s[40:41]
  s_mov_b64 s[24:25], s[54:55]
  s_mov_b64 s[20:21], s[48:49]
  s_mov_b64 s[36:37], s[68:69]
  s_mov_b64 s[28:29], s[58:59]
  s_cmp_ge_u32 s6, 4
  s_cbranch_scc1 L_gate
  s_barrier
  s_sub_u32 s78, s72, 28
  s_lshl_b32 s78, s78, 2
  s_add_u32 s78, s78, s70
  v_lshrrev_b32 v12, 1, v1
  v_mul_u32_u24 v12, 3584, v12
  v_and_b32 v13, 1, v1
  v_lshl_add_u32 v12, v13, 7, v12
  s_and_b32 s86, s71, 1
  s_mul_i32 s86, s86, 1792
L_pf1:
  s_lshr_b32 s79, s78, 1
  s_mul_i32 s80, s79, 147
  s_lshr_b32 s80, s80, 10
  s_mul_i32 s81, s80, 7
  s_sub_u32 s79, s79, s81
  s_lshl_b32 s80, s80, 1
  s_add_u32 s80, s80, s79
  s_cmp_ge_u32 s80, 7
  s_cselect_b32 s81, 7, 0
  s_sub_u32 s80, s80, s81
  s_lshl_b32 s80, s80, 1
  s_and_b32 s81, s78, 1
  s_add_u32 s80, s80, s81
  s_mul_i32 s80, s80, 114688
  s_lshl_b32 s79, s79, 8
  s_add_u32 s80, s80, s79
  s_add_u32 s80, s80, s86
  s_waitcnt vmcnt(1)
  buffer_load_dword v13, v12, s[24:27], s80 offen
  s_add_u32 s78, s78, 16
  s_cmp_lt_u32 s78, 42
  s_cbranch_scc1 L_pf1
  s_sub_u32 s78, s78, 42
  v_mul_u32_u24 v12, 896, v1
  s_and_b32 s86, s71, 1
  s_mul_i32 s86, s86, 802816
  s_lshr_b32 s84, s71, 1
  s_mul_i32 s84, s84, 3
  s_add_u32 s84, s84, 1
  s_and_b32 s84, s84, 14
L_pf:
  s_mov_b32 s77, s78
  s_mul_i32 s80, s77, 147
  s_lshr_b32 s80, s80, 10
  s_mul_i32 s81, s80, 7
  s_sub_u32 s79, s77, s81
  s_add_u32 s81, s80, s84
  s_cmp_ge_u32 s81, 14
  s_cselect_b32 s87, 12, 0
  s_sub_u32 s81, s81, s87
  s_cmp_ge_u32 s80, 2
  s_cselect_b32 s80, s81, s80
  s_lshl_b32 s81, s79, 1
  s_add_u32 s80, s80, s81
  s_cmp_ge_u32 s80, 14
  s_cselect_b32 s81, 14, 0
  s_sub_u32 s80, s80, s81
  s_mul_i32 s80, s80, 57344
  s_lshl_b32 s79, s79, 7
  s_add_u32 s79, s79, s80
  s_add_u32 s79, s79, s86
  s_waitcnt vmcnt(1)
  buffer_load_dword v13, v12, s[28:31], s79 offen
  s_add_u32 s78, s78, 16
  s_cmp_lt_u32 s78, 98
  s_cbranch_scc1 L_pf
  s_branch L_spare_done
L_gate:
  v_mov_b32 v12, 0
  buffer_load_dword v2, v12, s[36:39], 0 offen sc1
  s_sub_u32 s73, s72, 28
  s_lshl_b32 s77, s71, 2
  s_add_u32 s73, s73, s77
  s_lshl_b32 s77, s73, 6
  s_lshl_b32 s81, s70, 4
  s_add_u32 s77, s77, s81
  v_lshrrev_b32 v11, 3, v1
  v_add_u32 v11, s77, v11
  v_and_b32 v15, 7, v1
  v_lshlrev_b32 v15, 4, v15
  v_mul_u32_u24 v14, 896, v11
  v_add_u32 v14, v14, v15
  s_mov_b32 s79, 7168
  global_load_dwordx4 v[80:83], v15, s[62:63] offset:0
  global_load_dwordx4 v[84:87], v15, s[62:63] offset:128
  global_load_dwordx4 v[88:91], v15, s[62:63] offset:256
  global_load_dwordx4 v[92:95], v15, s[62:63] offset:384
  global_load_dwordx4 v[96:99], v15, s[62:63] offset:512
  global_load_dwordx4 v[100:103], v15, s[62:63] offset:640
  global_load_dwordx4 v[104:107], v15, s[62:63] offset:768
  buffer_load_dwordx4 v[16:19], v14, s[8:11], 0 offen offset:0
  buffer_load_dwordx4 v[20:23], v14, s[8:11], 0 offen offset:128
  buffer_load_dwordx4 v[24:27], v14, s[8:11], 0 offen offset:256
  buffer_load_dwordx4 v[28:31], v14, s[8:11], 0 offen offset:384
  buffer_load_dwordx4 v[32:35], v14, s[8:11], 0 offen offset:512
  buffer_load_dwordx4 v[36:39], v14, s[8:11], 0 offen offset:640
  buffer_load_dwordx4 v[40:43], v14, s[8:11], 0 offen offset:768
  buffer_load_dwordx4 v[44:47], v14, s[8:11], s79 offen offset:0
  buffer_load_dwordx4 v[48:51], v14, s[8:11], s79 offen offset:128
  buffer_load_dwordx4 v[52:55], v14, s[8:11], s79 offen offset:256
  buffer_load_dwordx4 v[56:59], v14, s[8:11], s79 offen offset:384
  buffer_load_dwordx4 v[60:63], v14, s[8:11], s79 offen offset:512
  buffer_load_dwordx4 v[64:67], v14, s[8:11], s79 offen offset:640
  buffer_load_dwordx4 v[68:71], v14, s[8:11], s79 offen offset:768
  s_waitcnt vmcnt(0)
  s_barrier
  s_waitcnt vmcnt(0)
  v_add_u32 v2, 0x9e3779b9, v2
  v_dot2_f32_bf16 v140, v16, v80, 0
  v_dot2_f32_bf16 v141, v17, v81, 0
  v_dot2_f32_bf16 v140, v18, v82, v140
  v_dot2_f32_bf16 v141, v19, v83, v141
  v_dot2_f32_bf16 v140, v20, v84, v140
  v_dot2_f32_bf16 v141, v21, v85, v141
  v_dot2_f32_bf16 v140, v22, v86, v140
  v_dot2_f32_bf16 v141, v23, v87, v141
  v_dot2_f32_bf16 v140, v24, v88, v140
  v_dot2_f32_bf16 v141, v25, v89, v141
  v_dot2_f32_bf16 v140, v26, v90, v140
  v_dot2_f32_bf16 v141, v27, v91, v141
  v_dot2_f32_bf16 v140, v28, v92, v140
  v_dot2_f32_bf16 v141, v29, v93, v141
  v_dot2_f32_bf16 v140, v30, v94, v140
  v_dot2_f32_bf16 v141, v31, v95, v141
  v_dot2_f32_bf16 v140, v32, v96, v140
  v_dot2_f32_bf16 v141, v33, v97, v141
  v_dot2_f32_bf16 v140, v34, v98, v140
  v_dot2_f32_bf16 v141, v35, v99, v141
  v_dot2_f32_bf16 v140, v36, v100, v140
  v_dot2_f32_bf16 v141, v37, v101, v141
  v_dot2_f32_bf16 v140, v38, v102, v140
  v_dot2_f32_bf16 v141, v39, v103, v141
  v_dot2_f32_bf16 v140, v40, v104, v140
  v_dot2_f32_bf16 v141, v41, v105, v141
  v_dot2_f32_bf16 v140, v42, v106, v140
  v_dot2_f32_bf16 v141, v43, v107, v141
  v_dot2_f32_bf16 v142, v44, v80, 0
  v_dot2_f32_bf16 v143, v45, v81, 0
  v_dot2_f32_bf16 v142, v46, v82, v142
  v_dot2_f32_bf16 v143, v47, v83, v143
  v_dot2_f32_bf16 v142, v48, v84, v142
  v_dot2_f32_bf16 v143, v49, v85, v143
  v_dot2_f32_bf16 v142, v50, v86, v142
  v_dot2_f32_bf16 v143, v51, v87, v143
  v_dot2_f32_bf16 v142, v52, v88, v142
  v_dot2_f32_bf16 v143, v53, v89, v143
  v_dot2_f32_bf16 v142, v54, v90, v142
  v_dot2_f32_bf16 v143, v55, v91, v143
  v_dot2_f32_bf16 v142, v56, v92, v142
  v_dot2_f32_bf16 v143, v57, v93, v143
  v_dot2_f32_bf16 v142, v58, v94, v142
  v_dot2_f32_bf16 v143, v59, v95, v143
  v_dot2_f32_bf16 v142, v60, v96, v142
  v_dot2_f32_bf16 v143, v61, v97, v143
  v_dot2_f32_bf16 v142, v62, v98, v142
  v_dot2_f32_bf16 v143, v63, v99, v143
  v_dot2_f32_bf16 v142, v64, v100, v142
  v_dot2_f32_bf16 v143, v65, v101, v143
  v_dot2_f32_bf16 v142, v66, v102, v142
  v_dot2_f32_bf16 v143, v67, v103, v143
  v_dot2_f32_bf16 v142, v68, v104, v142
  v_dot2_f32_bf16 v143, v69, v105, v143
  v_dot2_f32_bf16 v142, v70, v106, v142
  v_dot2_f32_bf16 v143, v71, v107, v143
  v_add_f32 v140, v140, v141
  s_nop 1
  v_add_f32 v142, v142, v143
  v_add_f32_dpp v140, v140, v140 quad_perm:[1,0,3,2] row_mask:0xf bank_mask:0xf
  s_nop 0
  v_add_f32_dpp v142, v142, v142 quad_perm:[1,0,3,2] row_mask:0xf bank_mask:0xf
  v_add_f32_dpp v140, v140, v140 quad_perm:[2,3,0,1] row_mask:0xf bank_mask:0xf
  s_nop 0
  v_add_f32_dpp v142, v142, v142 quad_perm:[2,3,0,1] row_mask:0xf bank_mask:0xf
  v_add_f32_dpp v140, v140, v140 row_half_mirror row_mask:0xf bank_mask:0xf
  s_nop 0
  v_add_f32_dpp v142, v142, v142 row_half_mirror row_mask:0xf bank_mask:0xf
  v_and_b32 v15, 1, v1
  v_cmp_eq_u32 vcc, 1, v15
  s_nop 1
  v_cndmask_b32 v140, v140, v142, vcc
  v_mul_f32 v140, 0xbfb8aa3b, v140
  v_exp_f32 v140, v140
  s_nop 0
  v_add_f32 v140, 1.0, v140
  v_rcp_f32 v140, v140
  v_mov_b32 v141, v2
  v_lshl_add_u32 v11, v15, 3, v11
  v_lshlrev_b32 v11, 3, v11
  v_add_u32 v11, 0x8000, v11
  s_mov_b32 exec_lo, 0x03030303
  s_mov_b32 exec_hi, 0x03030303
  buffer_store_dwordx2 v[140:141], v11, s[36:39], 0 offen sc1
  s_mov_b64 exec, -1
  s_cmp_lg_u32 s2, 255
  s_cbranch_scc1 L_spare_done
  s_cmp_lg_u32 s70, 0
  s_cbranch_scc1 L_spare_done
  s_waitcnt vmcnt(0)
  v_lshrrev_b32 v12, 3, v1
  v_mul_u32_u24 v12, 96, v12
  v_lshl_add_u32 v12, v1, 2, v12
  v_lshlrev_b32 v13, 7, v1
  v_add_u32 v13, 0x8004, v13
  v_add_u32 v14, 8192, v13
  s_mov_b32 s85, 0
L_upd:
  s_sleep 8
  s_mov_b32 s78, 0x60000
  buffer_load_dword v18, v12, s[36:39], s78 offen sc1
  s_mov_b32 s78, 0x60400
  buffer_load_dword v19, v12, s[36:39], s78 offen sc1
  s_mov_b32 s78, 0x60800
  buffer_load_dword v20, v12, s[36:39], s78 offen sc1
  s_mov_b32 s78, 0x60c00
  buffer_load_dword v21, v12, s[36:39], s78 offen sc1
  s_mov_b32 s78, 0x61000
  buffer_load_dword v22, v12, s[36:39], s78 offen sc1
  s_mov_b32 s78, 0x61400
  buffer_load_dword v23, v12, s[36:39], s78 offen sc1
  s_mov_b32 s78, 0x61800
  buffer_load_dword v24, v12, s[36:39], s78 offen sc1
  s_mov_b32 s78, 0x61c00
  buffer_load_dword v25, v12, s[36:39], s78 offen sc1
  s_mov_b32 s78, 0x62000
  buffer_load_dword v26, v12, s[36:39], s78 offen sc1
  s_mov_b32 s78, 0x62400
  buffer_load_dword v27, v12, s[36:39], s78 offen sc1
  s_mov_b32 s78, 0x62800
  buffer_load_dword v28, v12, s[36:39], s78 offen sc1
  s_mov_b32 s78, 0x62c00
  buffer_load_dword v29, v12, s[36:39], s78 offen sc1
  s_mov_b32 s78, 0x63000
  buffer_load_dword v30, v12, s[36:39], s78 offen sc1
  s_mov_b32 s78, 0x63400
  buffer_load_dword v31, v12, s[36:39], s78 offen sc1
  buffer_load_dword v32, v13, s[36:39], 0 offen sc1
  buffer_load_dword v33, v14, s[36:39], 0 offen sc1
  s_add_u32 s85, s85, 1
  s_waitcnt vmcnt(0)
  v_xor_b32 v18, v18, v2
  v_xor_b32 v19, v19, v2
  v_xor_b32 v20, v20, v2
  v_xor_b32 v21, v21, v2
  v_xor_b32 v22, v22, v2
  v_xor_b32 v23, v23, v2
  v_xor_b32 v24, v24, v2
  v_xor_b32 v25, v25, v2
  v_xor_b32 v26, v26, v2
  v_xor_b32 v27, v27, v2
  v_xor_b32 v28, v28, v2
  v_xor_b32 v29, v29, v2
  v_xor_b32 v30, v30, v2
  v_xor_b32 v31, v31, v2
  v_xor_b32 v32, v32, v2
  v_xor_b32 v33, v33, v2
  v_or_b32 v18, v18, v19
  v_or_b32 v18, v18, v20
  v_or_b32 v18, v18, v21
  v_or_b32 v18, v18, v22
  v_or_b32 v18, v18, v23
  v_or_b32 v18, v18, v24
  v_or_b32 v18, v18, v25
  v_or_b32 v18, v18, v26
  v_or_b32 v18, v18, v27
  v_or_b32 v18, v18, v28
  v_or_b32 v18, v18, v29
  v_or_b32 v18, v18, v30
  v_or_b32 v18, v18, v31
  v_or_b32 v18, v18, v32
  v_or_b32 v18, v18, v33
  v_cmp_ne_u32 vcc, 0, v18
  s_cmp_gt_u32 s85, 0x40000
  s_cbranch_scc1 L_upd_go
  s_cbranch_vccnz L_upd
L_upd_go:
  v_mov_b32 v12, 0
  s_mov_b64 exec, 1
  buffer_store_dword v2, v12, s[36:39], 0 offen sc1
  s_mov_b64 exec, -1
L_spare_done:
L_end:
  s_endpgm
L_code_end:
.section .rodata,"a"
.p2align 6
.amdhsa_kernel gated_mix__ssm_conv_h3__dense_activation_gelu__prompt_kernel
  .amdhsa_next_free_vgpr 256
  .amdhsa_next_free_sgpr 102
  .amdhsa_accum_offset 256
  .amdhsa_group_segment_fixed_size 0
  .amdhsa_kernarg_size 120
  .amdhsa_user_sgpr_count 2
  .amdhsa_user_sgpr_kernarg_segment_ptr 1
  .amdhsa_system_sgpr_workgroup_id_x 1
.end_amdhsa_kernel
```
